```python
import torch

def _softmax(x, axis=-1):
    return torch.softmax(x, dim=axis)
def _gelu(x):
    return torch.nn.functional.gelu(x, approximate="tanh")
def _silu(x):
    return torch.nn.functional.silu(x)
def _sigmoid(x):
    return torch.sigmoid(x)
def _layernorm(x, axis=-1, eps=1e-5):
    m = x.mean(dim=axis, keepdim=True)
    v = x.var(dim=axis, keepdim=True, unbiased=False)
    return (x - m) / torch.sqrt(v + eps)
def _scatter_add(tgt, idx, src, axis=0):
    return tgt.clone().index_add_(axis, idx, src)
def _segment_sum(src, seg, n):
    out = torch.zeros((n,) + src.shape[1:], dtype=src.dtype)
    return out.index_add_(0, seg, src)
def _pad(x, pw):
    flat = tuple(v for pair in reversed(pw) for v in pair)
    return torch.nn.functional.pad(x, flat)

kernel_name = 'standalone__gqa_block_cached__near_ridge'

def setup_inputs():

    _w = (lambda a: (lambda t: t.to(torch.bfloat16) if t.is_floating_point() else t)(torch.as_tensor(a)))
    B, Sq, D = 8, 48, 1024
    Hq, Hkv, Sk, Dh = 32, 4, 1024, 128
    assert Hq % Hkv == 0, (Hq, Hkv)
    return {
        "x": _w((lambda *s: torch.randn(*s, dtype=torch.bfloat16) * 0.8)(B, Sq, D)),
        "k_cache": _w((lambda *s: torch.randn(*s, dtype=torch.bfloat16) * 0.8)(B, Hkv, Sk, Dh)),
        "v_cache": _w((lambda *s: torch.randn(*s, dtype=torch.bfloat16) * 0.05)(B, Hkv, Sk, Dh)),
        "wq": _w((lambda *s: torch.randn(*s, dtype=torch.bfloat16) * 0.8)(D, Hq * Dh) * (D ** -0.5)),
        "wo": _w((lambda *s: torch.randn(*s, dtype=torch.bfloat16) * 0.05)(Hq * Dh, D) * ((Hq * Dh) ** -0.5)),
    }

def reference(x, k_cache, v_cache, wq, wo):
    B, Sq, D = x.shape
    Hq, Dh = 32, 128
    Hkv = k_cache.shape[1]
    rep = Hq // Hkv
    q = (lambda x, *d: x.permute(*d))((x @ wq).reshape(B, Sq, Hq, Dh), 0, 2, 1, 3)
    k = (lambda x, n, axis: torch.repeat_interleave(x, n, dim=axis))(k_cache, rep, axis=1)
    v = (lambda x, n, axis: torch.repeat_interleave(x, n, dim=axis))(v_cache, rep, axis=1)
    scores = torch.einsum("bhqd,bhkd->bhqk", q, k) * (Dh ** -0.5)
    p = _softmax(scores, axis=-1)
    o = torch.einsum("bhqk,bhkd->bhqd", p, v)
    return (lambda x, *d: x.permute(*d))(o, 0, 2, 1, 3).reshape(B, Sq, Hq * Dh) @ wo
```

```asm
; @launch grid=(256,1,1) block=(512,1,1) lds=163840
.amdgcn_target "amdgcn-amd-amdhsa--gfx950"
.text
.globl standalone__gqa_block_cached__near_ridge_kernel
.p2align 8
.type standalone__gqa_block_cached__near_ridge_kernel,@function
standalone__gqa_block_cached__near_ridge_kernel:
    s_cmp_ge_u32 s2, 256
    s_cbranch_scc1 L_end
    s_load_dwordx2 s[4:5], s[0:1], 0
    s_load_dwordx2 s[16:17], s[0:1], 24
    s_load_dwordx2 s[8:9], s[0:1], 8
    s_load_dwordx2 s[12:13], s[0:1], 16
    s_load_dwordx2 s[20:21], s[0:1], 32
    s_load_dwordx2 s[24:25], s[0:1], 40
    s_load_dwordx2 s[32:33], s[0:1], 48
    s_load_dwordx2 s[28:29], s[0:1], 56
    v_lshrrev_b32 v1, 6, v0
    v_and_b32 v0, 63, v0
    s_mov_b32 s7, 0x20000
    v_readfirstlane_b32 s3, v1
    v_lshlrev_b32 v1, 4, v0
    s_cmp_lg_u32 s3, 0
    s_cbranch_scc1 L_nopf
    s_getpc_b64 s[60:61]
L_pcref:
    s_sub_u32 s60, s60, L_pcref-standalone__gqa_block_cached__near_ridge_kernel
    s_subb_u32 s61, s61, 0
    s_mov_b32 s62, L_codeend-standalone__gqa_block_cached__near_ridge_kernel
    s_mov_b32 s63, s7
    s_lshr_b32 s56, s2, 3
    s_lshl_b32 s56, s56, 10
    buffer_load_dwordx4 v[240:243], v1, s[60:63], s56 offen
L_nopf:
    s_and_b32 s37, s2, 3
    s_bfe_u32 s38, s2, 0x10002
    s_lshr_b32 s39, s2, 6
    s_bfe_u32 s40, s2, 0x30003
    s_lshl2_add_u32 s41, s38, s39
    s_lshl2_add_u32 s42, s41, s37
    s_lshl3_add_u32 s43, s42, s40
    s_and_b32 s36, s3, 3
    s_cmp_lt_u32 s3, 4
    s_cbranch_scc1 L_roleA
    s_mov_b32 s6, 786432
    s_mov_b32 s18, 8388608
    s_mov_b32 s19, s7
    s_mov_b32 s30, 268435456
    s_mov_b32 s31, s7
    v_lshrrev_b32 v4, 4, v0
    s_lshl_b32 s56, s36, 2
    v_add_u32 v5, s56, v4
    v_xor_b32 v6, v5, v0
    v_and_b32 v6, 15, v6
    v_lshlrev_b32 v6, 4, v6
    v_lshl_or_b32 v2, v5, 11, v6
    v_lshlrev_b32 v7, 1, v5
    v_xor_b32 v7, v7, v0
    v_and_b32 v7, 15, v7
    v_lshlrev_b32 v7, 4, v7
    v_add_u32 v8, s56, v5
    v_lshl_or_b32 v3, v8, 13, v7
    s_lshl_b32 s3, s36, 10
    s_lshl3_add_u32 s55, s37, s40
    s_lshl_b32 s55, s55, 8
    s_mov_b32 s52, 0x8000
    s_mov_b32 s53, 229376
    s_xor_b32 s56, s39, s40
    s_lshl3_add_u32 s44, s38, s56
    v_bfe_u32 v13, v2, 7, 1
    v_xor_b32 v13, s38, v13
    v_xor_b32 v13, 1, v13
    v_and_b32 v2, 0xffffff7f, v2
    s_mov_b32 s56, 393216
    v_mad_u32_u24 v2, v13, s56, v2
    s_mul_i32 s54, s39, 98304
    s_xor_b32 s56, s44, 0
    s_lshl_b32 s58, s56, 7
    s_add_u32 s58, s58, s54
    s_lshl_b32 s59, s56, 19
    s_add_u32 s59, s59, s55
    s_mov_b32 m0, s3
    s_lshr_b32 s60, s41, 1
    s_lshl2_add_u32 s60, s60, s37
    s_and_b32 s61, s41, 1
    s_lshl3_add_u32 s61, s61, s40
    s_lshl_b32 s62, s60, 9
    s_add_u32 s62, s62, s61
    s_add_u32 s62, s62, 32768
    s_lshl_b32 s63, s43, 7
    v_lshlrev_b32 v9, 7, v0
    v_lshlrev_b32 v12, 3, v0
    v_mov_b32 v10, 0
    v_mov_b32 v11, 0
    s_waitcnt lgkmcnt(0)
    s_cmp_lg_u32 s36, 0
    s_cbranch_scc1 L_noclr
    s_mov_b64 exec, 15
    buffer_store_byte v11, v9, s[28:31], s62 offen sc1
    buffer_store_dwordx2 v[10:11], v12, s[28:31], s63 offen sc1
    s_mov_b64 exec, -1
L_noclr:
    buffer_load_dwordx4 v2, s[4:7], s58 offen lds
    s_addk_i32 m0, 4096
    s_add_u32 s58, s58, s52
    buffer_load_dwordx4 v2, s[4:7], s58 offen lds
    s_addk_i32 m0, 4096
    s_add_u32 s58, s58, s52
    buffer_load_dwordx4 v2, s[4:7], s58 offen lds
    s_addk_i32 m0, 4096
    s_nop 0
    buffer_load_dwordx4 v3, s[16:19], s59 offen lds
    s_addk_i32 m0, 4096
    s_add_u32 s59, s59, s52
    buffer_load_dwordx4 v3, s[16:19], s59 offen lds
    s_addk_i32 m0, 4096
    s_add_u32 s59, s59, s53
    buffer_load_dwordx4 v3, s[16:19], s59 offen lds
    s_addk_i32 m0, 4096
    s_add_u32 s59, s59, s52
    buffer_load_dwordx4 v3, s[16:19], s59 offen lds
    s_mov_b32 s66, 0x76543210
    s_xor_b32 s56, s44, 1
    s_lshl_b32 s58, s56, 7
    s_add_u32 s58, s58, s54
    s_lshl_b32 s59, s56, 19
    s_add_u32 s59, s59, s55
    s_add_u32 m0, s3, 28672
    s_nop 0
    buffer_load_dwordx4 v2, s[4:7], s58 offen lds
    s_addk_i32 m0, 4096
    s_add_u32 s58, s58, s52
    buffer_load_dwordx4 v2, s[4:7], s58 offen lds
    s_addk_i32 m0, 4096
    s_add_u32 s58, s58, s52
    buffer_load_dwordx4 v2, s[4:7], s58 offen lds
    s_addk_i32 m0, 4096
    s_nop 0
    buffer_load_dwordx4 v3, s[16:19], s59 offen lds
    s_addk_i32 m0, 4096
    s_add_u32 s59, s59, s52
    buffer_load_dwordx4 v3, s[16:19], s59 offen lds
    s_addk_i32 m0, 4096
    s_add_u32 s59, s59, s53
    buffer_load_dwordx4 v3, s[16:19], s59 offen lds
    s_addk_i32 m0, 4096
    s_add_u32 s59, s59, s52
    buffer_load_dwordx4 v3, s[16:19], s59 offen lds
    s_cmp_lg_u32 s36, 0
    s_cbranch_scc1 L_noann
    s_lshl4_add_u32 s60, s60, s61
    s_getreg_b32 s56, hwreg(HW_REG_XCC_ID)
    s_and_b32 s56, s56, 15
    s_or_b32 s56, s56, 0x80
    s_lshl_b32 s57, s60, 3
    s_lshl_b32 s47, s56, s57
    s_andn2_b32 s60, s60, 3
    s_add_u32 s34, s32, s60
    s_addc_u32 s35, s33, 0
    s_waitcnt vmcnt(14)
    s_atomic_or s47, s[34:35], 0
L_noann:
L_first_end:
    s_mov_b32 s10, 8388608
    s_mov_b32 s11, s7
    s_mov_b32 s14, 8388608
    s_mov_b32 s15, s7
    s_mov_b32 s22, 8388608
    s_mov_b32 s23, s7
    v_lshl_or_b32 v247, v5, 8, v6
    v_lshl_or_b32 v248, v5, 8, v7
    s_mov_b32 s45, 0x3e0293ee
    v_mov_b32 v10, v2
    v_bfe_u32 v252, v0, 4, 1
    v_lshrrev_b32 v253, 5, v0
    v_lshl_or_b32 v252, v252, 1, v253
    v_xor_b32 v252, v252, v0
    v_and_b32 v252, 15, v252
    v_lshlrev_b32 v252, 4, v252
    v_and_b32 v253, 15, v0
    v_lshl_or_b32 v252, v253, 8, v252
    s_lshl_b32 s56, s36, 13
    v_add_u32 v2, s56, v252
    v_mov_b32 v249, v2
    v_mov_b32 v2, v10
    v_and_b32 v251, 15, v0
    v_lshlrev_b32 v251, 4, v251
    v_add_u32 v251, 49152, v251
    v_lshrrev_b32 v250, 4, v0
    v_min_u32 v250, 2, v250
    v_lshlrev_b32 v250, 8, v250
    s_lshl_b32 s56, s36, 2
    v_add3_u32 v250, s56, v251, v250
    v_lshlrev_b32 v254, 25, v0
    v_min_u32 v254, 0x1000000, v254
    v_lshlrev_b32 v254, 4, v254
    v_mov_b32 v255, 1
    s_lshl_b32 s68, s43, 7
    s_add_u32 s68, s68, s36
    s_lshr_b32 s56, s41, 1
    s_lshl2_add_u32 s56, s56, s37
    s_and_b32 s57, s41, 1
    s_lshl3_add_u32 s57, s57, s40
    s_lshl2_add_u32 s69, s56, s36
    s_lshl_b32 s69, s69, 7
    s_add_u32 s69, s69, s57
    s_add_u32 s69, s69, 32768
    v_lshlrev_b32 v15, 7, v0
    s_lshl_b32 s56, s36, 13
    v_add_u32 v15, s56, v15
    s_mov_b32 s59, 0x76532410
    s_and_b32 s56, s39, 1
    s_cmp_eq_u32 s56, 1
    s_cselect_b32 s59, 0x76532140, s59
    s_lshl_b32 s58, s42, 18
    s_and_b32 s56, s40, 1
    s_lshl_b32 s56, s56, 17
    s_add_u32 s58, s58, s56
    s_lshr_b32 s57, s40, 1
    s_bfe_u32 s56, s59, 0x30000
    s_xor_b32 s56, s56, s57
    s_lshl_b32 s56, s56, 14
    s_add_u32 s24, s56, s58
    s_bfe_u32 s56, s59, 0x30004
    s_xor_b32 s56, s56, s57
    s_lshl_b32 s56, s56, 14
    s_add_u32 s25, s56, s58
    s_bfe_u32 s56, s59, 0x30008
    s_xor_b32 s56, s56, s57
    s_lshl_b32 s56, s56, 14
    s_add_u32 s26, s56, s58
    s_bfe_u32 s56, s59, 0x3000c
    s_xor_b32 s56, s56, s57
    s_lshl_b32 s56, s56, 14
    s_add_u32 s27, s56, s58
    s_waitcnt vmcnt(7)
    s_barrier
    s_xor_b32 s56, s44, 2
    s_lshl_b32 s58, s56, 7
    s_add_u32 s58, s58, s54
    s_lshl_b32 s59, s56, 19
    s_add_u32 s59, s59, s55
    s_add_u32 m0, s3, 57344
    s_nop 0
    buffer_load_dwordx4 v2, s[4:7], s58 offen lds
    s_addk_i32 m0, 4096
    s_add_u32 s58, s58, s52
    buffer_load_dwordx4 v2, s[4:7], s58 offen lds
    s_addk_i32 m0, 4096
    s_add_u32 s58, s58, s52
    buffer_load_dwordx4 v2, s[4:7], s58 offen lds
    s_addk_i32 m0, 4096
    s_nop 0
    buffer_load_dwordx4 v3, s[16:19], s59 offen lds
    s_addk_i32 m0, 4096
    s_add_u32 s59, s59, s52
    buffer_load_dwordx4 v3, s[16:19], s59 offen lds
    s_addk_i32 m0, 4096
    s_add_u32 s59, s59, s53
    buffer_load_dwordx4 v3, s[16:19], s59 offen lds
    s_addk_i32 m0, 4096
    s_add_u32 s59, s59, s52
    buffer_load_dwordx4 v3, s[16:19], s59 offen lds
    s_waitcnt vmcnt(7)
    s_barrier
    s_xor_b32 s56, s44, 3
    s_lshl_b32 s58, s56, 7
    s_add_u32 s58, s58, s54
    s_lshl_b32 s59, s56, 19
    s_add_u32 s59, s59, s55
    s_mov_b32 m0, s3
    s_nop 0
    buffer_load_dwordx4 v2, s[4:7], s58 offen lds
    s_addk_i32 m0, 4096
    s_add_u32 s58, s58, s52
    buffer_load_dwordx4 v2, s[4:7], s58 offen lds
    s_addk_i32 m0, 4096
    s_add_u32 s58, s58, s52
    buffer_load_dwordx4 v2, s[4:7], s58 offen lds
    s_addk_i32 m0, 4096
    s_nop 0
    buffer_load_dwordx4 v3, s[16:19], s59 offen lds
    s_addk_i32 m0, 4096
    s_add_u32 s59, s59, s52
    buffer_load_dwordx4 v3, s[16:19], s59 offen lds
    s_addk_i32 m0, 4096
    s_add_u32 s59, s59, s53
    buffer_load_dwordx4 v3, s[16:19], s59 offen lds
    s_addk_i32 m0, 4096
    s_add_u32 s59, s59, s52
    buffer_load_dwordx4 v3, s[16:19], s59 offen lds
    s_waitcnt vmcnt(7)
    s_barrier
    s_xor_b32 s56, s44, 4
    s_lshl_b32 s58, s56, 7
    s_add_u32 s58, s58, s54
    s_lshl_b32 s59, s56, 19
    s_add_u32 s59, s59, s55
    s_add_u32 m0, s3, 28672
    s_nop 0
    buffer_load_dwordx4 v2, s[4:7], s58 offen lds
    s_addk_i32 m0, 4096
    s_add_u32 s58, s58, s52
    buffer_load_dwordx4 v2, s[4:7], s58 offen lds
    s_addk_i32 m0, 4096
    s_add_u32 s58, s58, s52
    buffer_load_dwordx4 v2, s[4:7], s58 offen lds
    s_addk_i32 m0, 4096
    s_nop 0
    buffer_load_dwordx4 v3, s[16:19], s59 offen lds
    s_addk_i32 m0, 4096
    s_add_u32 s59, s59, s52
    buffer_load_dwordx4 v3, s[16:19], s59 offen lds
    s_addk_i32 m0, 4096
    s_add_u32 s59, s59, s53
    buffer_load_dwordx4 v3, s[16:19], s59 offen lds
    s_addk_i32 m0, 4096
    s_add_u32 s59, s59, s52
    buffer_load_dwordx4 v3, s[16:19], s59 offen lds
    s_waitcnt vmcnt(7)
    s_barrier
    s_xor_b32 s56, s44, 5
    s_lshl_b32 s58, s56, 7
    s_add_u32 s58, s58, s54
    s_lshl_b32 s59, s56, 19
    s_add_u32 s59, s59, s55
    s_add_u32 m0, s3, 57344
    s_nop 0
    buffer_load_dwordx4 v2, s[4:7], s58 offen lds
    s_addk_i32 m0, 4096
    s_add_u32 s58, s58, s52
    buffer_load_dwordx4 v2, s[4:7], s58 offen lds
    s_addk_i32 m0, 4096
    s_add_u32 s58, s58, s52
    buffer_load_dwordx4 v2, s[4:7], s58 offen lds
    s_addk_i32 m0, 4096
    s_nop 0
    buffer_load_dwordx4 v3, s[16:19], s59 offen lds
    s_addk_i32 m0, 4096
    s_add_u32 s59, s59, s52
    buffer_load_dwordx4 v3, s[16:19], s59 offen lds
    s_addk_i32 m0, 4096
    s_add_u32 s59, s59, s53
    buffer_load_dwordx4 v3, s[16:19], s59 offen lds
    s_addk_i32 m0, 4096
    s_add_u32 s59, s59, s52
    buffer_load_dwordx4 v3, s[16:19], s59 offen lds
    s_waitcnt vmcnt(7)
    s_barrier
    s_xor_b32 s56, s44, 6
    s_lshl_b32 s58, s56, 7
    s_add_u32 s58, s58, s54
    s_lshl_b32 s59, s56, 19
    s_add_u32 s59, s59, s55
    s_mov_b32 m0, s3
    s_nop 0
    buffer_load_dwordx4 v2, s[4:7], s58 offen lds
    s_addk_i32 m0, 4096
    s_add_u32 s58, s58, s52
    buffer_load_dwordx4 v2, s[4:7], s58 offen lds
    s_addk_i32 m0, 4096
    s_add_u32 s58, s58, s52
    buffer_load_dwordx4 v2, s[4:7], s58 offen lds
    s_addk_i32 m0, 4096
    s_nop 0
    buffer_load_dwordx4 v3, s[16:19], s59 offen lds
    s_addk_i32 m0, 4096
    s_add_u32 s59, s59, s52
    buffer_load_dwordx4 v3, s[16:19], s59 offen lds
    s_addk_i32 m0, 4096
    s_add_u32 s59, s59, s53
    buffer_load_dwordx4 v3, s[16:19], s59 offen lds
    s_addk_i32 m0, 4096
    s_add_u32 s59, s59, s52
    buffer_load_dwordx4 v3, s[16:19], s59 offen lds
    s_lshr_b32 s56, s41, 1
    s_lshl2_add_u32 s56, s56, s37
    s_and_b32 s57, s41, 1
    s_lshl3_add_u32 s57, s57, s40
    s_lshl_b32 s56, s56, 4
    s_add_u32 s34, s32, s56
    s_addc_u32 s35, s33, 0
    s_load_dwordx4 s[60:63], s[34:35], 0
    s_getreg_b32 s56, hwreg(HW_REG_XCC_ID)
    s_and_b32 s56, s56, 15
    s_or_b32 s56, s56, 0x80
    s_mul_i32 s64, s56, 0x01010101
    s_mov_b32 s65, s64
    s_waitcnt vmcnt(7)
    s_barrier
    s_xor_b32 s56, s44, 7
    s_lshl_b32 s58, s56, 7
    s_add_u32 s58, s58, s54
    s_lshl_b32 s59, s56, 19
    s_add_u32 s59, s59, s55
    s_add_u32 m0, s3, 28672
    s_nop 0
    buffer_load_dwordx4 v2, s[4:7], s58 offen lds
    s_addk_i32 m0, 4096
    s_add_u32 s58, s58, s52
    buffer_load_dwordx4 v2, s[4:7], s58 offen lds
    s_addk_i32 m0, 4096
    s_add_u32 s58, s58, s52
    buffer_load_dwordx4 v2, s[4:7], s58 offen lds
    s_addk_i32 m0, 4096
    s_nop 0
    buffer_load_dwordx4 v3, s[16:19], s59 offen lds
    s_addk_i32 m0, 4096
    s_add_u32 s59, s59, s52
    buffer_load_dwordx4 v3, s[16:19], s59 offen lds
    s_addk_i32 m0, 4096
    s_add_u32 s59, s59, s53
    buffer_load_dwordx4 v3, s[16:19], s59 offen lds
    s_addk_i32 m0, 4096
    s_add_u32 s59, s59, s52
    buffer_load_dwordx4 v3, s[16:19], s59 offen lds
    s_add_u32 m0, s3, 102400
    s_add_u32 s59, s24, 0
    buffer_load_dwordx4 v247, s[8:11], s59 offen lds
    s_add_u32 m0, s3, 106496
    s_add_u32 s59, s24, 4096
    buffer_load_dwordx4 v247, s[8:11], s59 offen lds
    s_add_u32 m0, s3, 110592
    s_add_u32 s59, s24, 8192
    buffer_load_dwordx4 v247, s[8:11], s59 offen lds
    s_add_u32 m0, s3, 114688
    s_add_u32 s59, s24, 12288
    buffer_load_dwordx4 v247, s[8:11], s59 offen lds
    s_add_u32 m0, s3, 118784
    s_add_u32 s59, s25, 0
    buffer_load_dwordx4 v247, s[8:11], s59 offen lds
    s_add_u32 m0, s3, 122880
    s_add_u32 s59, s25, 4096
    buffer_load_dwordx4 v247, s[8:11], s59 offen lds
    s_add_u32 m0, s3, 126976
    s_add_u32 s59, s25, 8192
    buffer_load_dwordx4 v247, s[8:11], s59 offen lds
    s_add_u32 m0, s3, 131072
    s_add_u32 s59, s25, 12288
    buffer_load_dwordx4 v247, s[8:11], s59 offen lds
    s_waitcnt lgkmcnt(0)
    s_cmp_eq_u64 s[60:61], s[64:65]
    s_cselect_b32 s47, 1, 0
    s_cmp_eq_u64 s[62:63], s[64:65]
    s_cselect_b32 s47, s47, 0
    s_lshr_b32 s56, s41, 1
    s_lshl_b32 s56, s56, 6
    s_add_u32 s34, s32, s56
    s_addc_u32 s35, s33, 0
    s_load_dwordx8 s[60:67], s[34:35], 0
    s_waitcnt vmcnt(15)
    s_barrier
    s_mov_b32 s59, 0x76532410
    s_and_b32 s56, s39, 1
    s_cmp_eq_u32 s56, 1
    s_cselect_b32 s59, 0x76532140, s59
    s_lshl_b32 s58, s42, 18
    s_and_b32 s56, s40, 1
    s_lshl_b32 s56, s56, 17
    s_add_u32 s58, s58, s56
    s_lshr_b32 s57, s40, 1
    s_bfe_u32 s56, s59, 0x30010
    s_xor_b32 s56, s56, s57
    s_lshl_b32 s56, s56, 14
    s_add_u32 s4, s56, s58
    s_bfe_u32 s56, s59, 0x30014
    s_xor_b32 s56, s56, s57
    s_lshl_b32 s56, s56, 14
    s_add_u32 s5, s56, s58
    s_bfe_u32 s56, s59, 0x30018
    s_xor_b32 s56, s56, s57
    s_lshl_b32 s56, s56, 14
    s_add_u32 s6, s56, s58
    s_bfe_u32 s56, s59, 0x3001c
    s_xor_b32 s56, s56, s57
    s_lshl_b32 s56, s56, 14
    s_add_u32 s16, s56, s58
    v_mov_b32 v2, v248
    s_waitcnt lgkmcnt(0)
    s_and_b64 s[60:61], s[60:61], s[62:63]
    s_and_b64 s[64:65], s[64:65], s[66:67]
    s_and_b64 s[60:61], s[60:61], s[64:65]
    s_and_b32 s60, s60, s61
    s_mov_b32 s19, s60
    s_lshr_b32 s56, s41, 1
    s_lshl_b32 s56, s56, 6
    s_add_u32 s34, s32, s56
    s_addc_u32 s35, s33, 0
    s_load_dwordx8 s[60:67], s[34:35], 32
    s_lshr_b32 s56, s41, 1
    s_lshl2_add_u32 s56, s56, s37
    s_and_b32 s57, s41, 1
    s_lshl3_add_u32 s57, s57, s40
    s_lshl4_add_u32 s56, s56, s57
    s_xor_b32 s56, s56, 128
    s_andn2_b32 s56, s56, 3
    s_add_u32 s34, s32, s56
    s_addc_u32 s35, s33, 0
    s_load_dword s54, s[34:35], 0
    s_xor_b32 s56, s43, 1
    s_lshl_b32 s56, s56, 7
    s_add_u32 s34, s28, s56
    s_addc_u32 s35, s29, 0
    s_load_dwordx2 s[0:1], s[34:35], 60
    s_andn2_b32 s56, s69, 127
    s_add_u32 s34, s28, s56
    s_addc_u32 s35, s29, 0
    s_load_dwordx2 s[52:53], s[34:35], 60
    s_waitcnt vmcnt(8)
    s_barrier
    s_waitcnt lgkmcnt(0)
    s_and_b64 s[60:61], s[60:61], s[62:63]
    s_and_b64 s[64:65], s[64:65], s[66:67]
    s_and_b64 s[60:61], s[60:61], s[64:65]
    s_and_b32 s60, s60, s61
    s_and_b32 s60, s60, s19
    s_and_b32 s60, s60, s54
    s_and_b32 s60, s60, 0x80808080
    s_cmp_eq_u32 s60, 0x80808080
    s_cbranch_scc1 L_dbgok_1
    s_mov_b32 s60, s32
    s_mov_b32 s61, s33
    s_mov_b32 s62, 256
    s_mov_b32 s63, 0x20000
    v_lshlrev_b32 v253, 2, v0
    s_mov_b32 s46, 0
L_dbg_2:
    s_add_u32 s46, s46, 1
    s_cmp_gt_u32 s46, 1048576
    s_cbranch_scc1 L_end
    buffer_load_dword v252, v253, s[60:63], 0 offen sc1
    s_waitcnt vmcnt(0)
    v_and_b32 v252, 0x80808080, v252
    v_cmp_ne_u32 vcc, 0x80808080, v252
    s_nop 4
    s_cbranch_vccnz L_dbg_2
L_dbgok_1:
    s_xor_b32 s17, s43, 1
    s_lshl_b32 s17, s17, 7
    s_add_u32 s34, s28, s17
    s_addc_u32 s35, s29, 0
    s_lshl_b32 s33, s36, 3
    s_lshl_b32 s33, 1, s33
    s_mov_b32 s19, 0
    s_lshl2_add_u32 s32, s43, s36
    s_lshl_b32 s32, s32, 12
    s_add_u32 s32, s32, 65536
    v_mov_b32 v240, -1
    v_mov_b32 v241, -1
    v_mov_b32 v242, -1
    v_mov_b32 v243, -1
    v_lshlrev_b32 v246, 7, v0
    s_lshl_b32 s58, s37, 21
    s_lshl2_add_u32 s56, s40, s36
    s_lshl_b32 s56, s56, 13
    s_add_u32 s58, s58, s56
    s_lshr_b32 s0, s41, 1
    s_and_b32 s56, s41, 1
    s_lshl2_add_u32 s0, s56, s0
    s_xor_b32 s1, s0, 2
    s_lshl_b32 s0, s0, 18
    s_add_u32 s0, s0, s58
    s_lshl_b32 s1, s1, 18
    s_add_u32 s1, s1, s58
    v_lshl_or_b32 v3, v5, 11, v7
    v_bfe_u32 v252, v0, 2, 3
    s_lshl_b32 s56, s36, 1
    v_xor_b32 v252, s56, v252
    v_lshlrev_b32 v252, 5, v252
    v_lshrrev_b32 v253, 2, v0
    v_lshl_or_b32 v252, v253, 8, v252
    v_and_b32 v253, 3, v0
    v_lshl_or_b32 v7, v253, 3, v252
    v_xor_b32 v8, 32, v7
    v_add_u32 v9, 114688, v7
    v_add_u32 v10, 114688, v8
    s_mov_b32 s59, 0x3102
    s_and_b32 s56, s40, 1
    s_cmp_eq_u32 s56, 1
    s_cselect_b32 s59, 0x3120, s59
    s_lshr_b32 s58, s41, 1
    s_and_b32 s56, s41, 1
    s_lshl2_add_u32 s58, s56, s58
    s_lshl_b32 s57, s37, 21
    s_lshl_b32 s56, s40, 8
    s_add_u32 s57, s57, s56
    s_bfe_u32 s56, s59, 0x20000
    s_xor_b32 s56, s56, s58
    s_lshl_b32 s56, s56, 18
    s_add_u32 s48, s56, s57
    s_bfe_u32 s56, s59, 0x20004
    s_xor_b32 s56, s56, s58
    s_lshl_b32 s56, s56, 18
    s_add_u32 s49, s56, s57
    s_bfe_u32 s56, s59, 0x20008
    s_xor_b32 s56, s56, s58
    s_lshl_b32 s56, s56, 18
    s_add_u32 s50, s56, s57
    s_bfe_u32 s56, s59, 0x2000c
    s_xor_b32 s56, s56, s58
    s_lshl_b32 s56, s56, 18
    s_add_u32 s51, s56, s57
    s_barrier
    s_add_u32 m0, s3, 0
    s_add_u32 s59, s26, 0
    buffer_load_dwordx4 v247, s[8:11], s59 offen lds
    s_add_u32 m0, s3, 4096
    s_add_u32 s59, s26, 4096
    buffer_load_dwordx4 v247, s[8:11], s59 offen lds
    s_add_u32 m0, s3, 8192
    s_add_u32 s59, s26, 8192
    buffer_load_dwordx4 v247, s[8:11], s59 offen lds
    s_add_u32 m0, s3, 12288
    s_add_u32 s59, s26, 12288
    buffer_load_dwordx4 v247, s[8:11], s59 offen lds
    s_add_u32 m0, s3, 16384
    s_add_u32 s59, s27, 0
    s_waitcnt vmcnt(11)
    buffer_load_dwordx4 v247, s[8:11], s59 offen lds
    s_add_u32 m0, s3, 20480
    s_add_u32 s59, s27, 4096
    s_waitcnt vmcnt(11)
    buffer_load_dwordx4 v247, s[8:11], s59 offen lds
    s_add_u32 m0, s3, 24576
    s_add_u32 s59, s27, 8192
    s_waitcnt vmcnt(11)
    buffer_load_dwordx4 v247, s[8:11], s59 offen lds
    s_add_u32 m0, s3, 28672
    s_add_u32 s59, s27, 12288
    s_waitcnt vmcnt(11)
    buffer_load_dwordx4 v247, s[8:11], s59 offen lds
    s_add_u32 m0, s3, 32768
    s_add_u32 s59, s4, 0
    s_waitcnt vmcnt(11)
    buffer_load_dwordx4 v247, s[8:11], s59 offen lds
    s_add_u32 m0, s3, 36864
    s_add_u32 s59, s4, 4096
    s_waitcnt vmcnt(11)
    buffer_load_dwordx4 v247, s[8:11], s59 offen lds
    s_add_u32 m0, s3, 40960
    s_add_u32 s59, s4, 8192
    s_waitcnt vmcnt(11)
    buffer_load_dwordx4 v247, s[8:11], s59 offen lds
    s_add_u32 m0, s3, 45056
    s_add_u32 s59, s4, 12288
    s_waitcnt vmcnt(11)
    buffer_load_dwordx4 v247, s[8:11], s59 offen lds
    s_add_u32 m0, s3, 49152
    s_add_u32 s59, s5, 0
    s_waitcnt vmcnt(11)
    buffer_load_dwordx4 v247, s[8:11], s59 offen lds
    s_add_u32 m0, s3, 53248
    s_add_u32 s59, s5, 4096
    s_waitcnt vmcnt(11)
    buffer_load_dwordx4 v247, s[8:11], s59 offen lds
    s_add_u32 m0, s3, 57344
    s_add_u32 s59, s5, 8192
    s_waitcnt vmcnt(11)
    buffer_load_dwordx4 v247, s[8:11], s59 offen lds
    s_add_u32 m0, s3, 61440
    s_add_u32 s59, s5, 12288
    s_waitcnt vmcnt(11)
    buffer_load_dwordx4 v247, s[8:11], s59 offen lds
    s_add_u32 m0, s3, 65536
    s_add_u32 s59, s6, 0
    s_waitcnt vmcnt(11)
    buffer_load_dwordx4 v247, s[8:11], s59 offen lds
    s_add_u32 m0, s3, 69632
    s_add_u32 s59, s6, 4096
    s_waitcnt vmcnt(11)
    buffer_load_dwordx4 v247, s[8:11], s59 offen lds
    s_add_u32 m0, s3, 73728
    s_add_u32 s59, s6, 8192
    s_waitcnt vmcnt(11)
    buffer_load_dwordx4 v247, s[8:11], s59 offen lds
    s_add_u32 m0, s3, 77824
    s_add_u32 s59, s6, 12288
    s_waitcnt vmcnt(11)
    buffer_load_dwordx4 v247, s[8:11], s59 offen lds
    s_add_u32 m0, s3, 81920
    s_add_u32 s59, s16, 0
    s_waitcnt vmcnt(11)
    buffer_load_dwordx4 v247, s[8:11], s59 offen lds
    s_add_u32 m0, s3, 86016
    s_add_u32 s59, s16, 4096
    s_waitcnt vmcnt(11)
    buffer_load_dwordx4 v247, s[8:11], s59 offen lds
    s_add_u32 m0, s3, 147456
    s_add_u32 s59, s16, 8192
    s_waitcnt vmcnt(11)
    buffer_load_dwordx4 v247, s[8:11], s59 offen lds
    s_add_u32 m0, s3, 151552
    s_add_u32 s59, s16, 12288
    s_waitcnt vmcnt(11)
    buffer_load_dwordx4 v247, s[8:11], s59 offen lds
    s_cmp_lt_u32 s36, 2
    s_cselect_b32 s56, s24, s25
    s_and_b32 s57, s36, 1
    s_lshl_b32 s57, s57, 13
    s_add_u32 s18, s56, s57
    s_cmp_lt_u32 s36, 1
    s_cselect_b32 s18, s18, 0x1000000
    s_waitcnt vmcnt(8)
    s_barrier
    buffer_load_dword v245, v246, s[12:15], s18 offen
    v_add_u32 v11, 102400, v249
    v_xor_b32 v12, 64, v11
    v_xor_b32 v13, 128, v11
    v_xor_b32 v14, 192, v11
    ds_read_b128 v[64:67], v11 offset:0
    ds_read_b128 v[80:83], v11 offset:4096
    ds_read_b128 v[68:71], v12 offset:0
    ds_read_b128 v[84:87], v12 offset:4096
    ds_read_b128 v[72:75], v13 offset:0
    ds_read_b128 v[88:91], v13 offset:4096
    ds_read_b128 v[76:79], v14 offset:0
    ds_read_b128 v[92:95], v14 offset:4096
    s_waitcnt lgkmcnt(6)
    v_add_u32 v11, 0, v249
    v_xor_b32 v12, 64, v11
    v_xor_b32 v13, 128, v11
    v_xor_b32 v14, 192, v11
    ds_read_b128 v[96:99], v11 offset:0
    ds_read_b128 v[112:115], v11 offset:4096
    ds_read_b128 v[100:103], v12 offset:0
    ds_read_b128 v[116:119], v12 offset:4096
    ds_read_b128 v[104:107], v13 offset:0
    ds_read_b128 v[120:123], v13 offset:4096
    ds_read_b128 v[108:111], v14 offset:0
    ds_read_b128 v[124:127], v14 offset:4096
    s_waitcnt lgkmcnt(6)
    v_add_u32 v11, 32768, v249
    v_xor_b32 v12, 64, v11
    v_xor_b32 v13, 128, v11
    v_xor_b32 v14, 192, v11
    ds_read_b128 v[128:131], v11 offset:0
    ds_read_b128 v[144:147], v11 offset:4096
    ds_read_b128 v[132:135], v12 offset:0
    ds_read_b128 v[148:151], v12 offset:4096
    ds_read_b128 v[136:139], v13 offset:0
    ds_read_b128 v[152:155], v13 offset:4096
    ds_read_b128 v[140:143], v14 offset:0
    ds_read_b128 v[156:159], v14 offset:4096
    s_waitcnt vmcnt(1)
    s_waitcnt lgkmcnt(0)
    s_barrier
    s_mov_b32 s56, 65536
    s_cmp_eq_u32 s36, 3
    s_cselect_b32 s56, 122880, s56
    v_add_u32 v11, s56, v249
    v_xor_b32 v12, 64, v11
    v_xor_b32 v13, 128, v11
    v_xor_b32 v14, 192, v11
    ds_read_b128 v[160:163], v11 offset:0
    ds_read_b128 v[176:179], v11 offset:4096
    ds_read_b128 v[164:167], v12 offset:0
    ds_read_b128 v[180:183], v12 offset:4096
    ds_read_b128 v[168:171], v13 offset:0
    ds_read_b128 v[184:187], v13 offset:4096
    ds_read_b128 v[172:175], v14 offset:0
    ds_read_b128 v[188:191], v14 offset:4096
    v_and_b32 v253, 0, v0
    v_lshlrev_b32 v253, 2, v253
    s_mov_b32 s46, 0
L_poll_3:
    s_add_u32 s46, s46, 1
    s_cmp_gt_u32 s46, 1048576
    s_cbranch_scc1 L_end
    buffer_load_dword v252, v253, s[28:31], s17 offen offset:0 sc1
    s_waitcnt vmcnt(0)
    v_cmp_ne_u32 vcc, 0x01010101, v252
    s_nop 4
    s_cbranch_vccnz L_poll_3
    s_mul_i32 s56, s36, 3072
    s_add_u32 m0, s56, 90112
    s_mov_b32 s19, 1
    buffer_load_dwordx4 v1, s[28:31], s32 offen offset:0 sc1 lds
    buffer_load_dwordx4 v1, s[28:31], s32 offen offset:1024 sc1 lds
    buffer_load_dwordx4 v1, s[28:31], s32 offen offset:2048 sc1 lds
    s_add_u32 m0, s3, 0
    s_add_u32 s59, s24, 0
    buffer_load_dwordx4 v2, s[12:15], s59 offen lds
    s_add_u32 m0, s3, 4096
    s_add_u32 s59, s24, 4096
    buffer_load_dwordx4 v2, s[12:15], s59 offen lds
    s_add_u32 m0, s3, 8192
    s_add_u32 s59, s24, 8192
    buffer_load_dwordx4 v2, s[12:15], s59 offen lds
    s_add_u32 m0, s3, 12288
    s_add_u32 s59, s24, 12288
    buffer_load_dwordx4 v2, s[12:15], s59 offen lds
    v_add_u32 v249, 90112, v1
    s_waitcnt vmcnt(4)
    s_add_u32 m0, s3, 16384
    s_add_u32 s59, s25, 0
    buffer_load_dwordx4 v2, s[12:15], s59 offen lds
    s_add_u32 m0, s3, 20480
    s_add_u32 s59, s25, 4096
    buffer_load_dwordx4 v2, s[12:15], s59 offen lds
    s_add_u32 m0, s3, 24576
    s_add_u32 s59, s25, 8192
    buffer_load_dwordx4 v2, s[12:15], s59 offen lds
    s_add_u32 m0, s3, 28672
    s_add_u32 s59, s25, 12288
    buffer_load_dwordx4 v2, s[12:15], s59 offen lds
    s_waitcnt lgkmcnt(0)
    s_barrier
    ds_read_b128 v[16:19], v249 offset:0
    ds_read_b128 v[20:23], v249 offset:1024
    ds_read_b128 v[24:27], v249 offset:2048
    ds_read_b128 v[28:31], v249 offset:3072
    ds_read_b128 v[32:35], v249 offset:4096
    ds_read_b128 v[36:39], v249 offset:5120
    ds_read_b128 v[40:43], v249 offset:6144
    ds_read_b128 v[44:47], v249 offset:7168
    ds_read_b128 v[48:51], v249 offset:8192
    ds_read_b128 v[52:55], v249 offset:9216
    ds_read_b128 v[56:59], v249 offset:10240
    ds_read_b128 v[60:63], v249 offset:11264
    v_mov_b32 v11, v246
    s_waitcnt lgkmcnt(9)
    v_mfma_f32_16x16x32_bf16 v[192:195], v[64:67], v[16:19], 0
    v_mfma_f32_16x16x32_bf16 v[196:199], v[64:67], v[20:23], 0
    v_mfma_f32_16x16x32_bf16 v[200:203], v[64:67], v[24:27], 0
    v_mfma_f32_16x16x32_bf16 v[204:207], v[80:83], v[16:19], 0
    v_mfma_f32_16x16x32_bf16 v[208:211], v[80:83], v[20:23], 0
    v_mfma_f32_16x16x32_bf16 v[212:215], v[80:83], v[24:27], 0
    s_waitcnt lgkmcnt(6)
    v_mfma_f32_16x16x32_bf16 v[192:195], v[68:71], v[28:31], v[192:195]
    s_add_u32 m0, s3, 53248
    s_add_u32 s59, s26, 0
    buffer_load_dwordx4 v2, s[12:15], s59 offen lds
    v_mfma_f32_16x16x32_bf16 v[196:199], v[68:71], v[32:35], v[196:199]
    v_mfma_f32_16x16x32_bf16 v[200:203], v[68:71], v[36:39], v[200:203]
    s_add_u32 m0, s3, 57344
    s_add_u32 s59, s26, 4096
    buffer_load_dwordx4 v2, s[12:15], s59 offen lds
    v_mfma_f32_16x16x32_bf16 v[204:207], v[84:87], v[28:31], v[204:207]
    v_mfma_f32_16x16x32_bf16 v[208:211], v[84:87], v[32:35], v[208:211]
    s_add_u32 m0, s3, 102400
    s_add_u32 s59, s26, 8192
    buffer_load_dwordx4 v2, s[12:15], s59 offen lds
    v_mfma_f32_16x16x32_bf16 v[212:215], v[84:87], v[36:39], v[212:215]
    s_waitcnt lgkmcnt(3)
    v_mfma_f32_16x16x32_bf16 v[192:195], v[72:75], v[40:43], v[192:195]
    s_add_u32 m0, s3, 106496
    s_add_u32 s59, s26, 12288
    buffer_load_dwordx4 v2, s[12:15], s59 offen lds
    v_mfma_f32_16x16x32_bf16 v[196:199], v[72:75], v[44:47], v[196:199]
    v_mfma_f32_16x16x32_bf16 v[200:203], v[72:75], v[48:51], v[200:203]
    s_add_u32 m0, s3, 61440
    s_add_u32 s59, s27, 0
    buffer_load_dwordx4 v2, s[12:15], s59 offen lds
    v_mfma_f32_16x16x32_bf16 v[204:207], v[88:91], v[40:43], v[204:207]
    v_mfma_f32_16x16x32_bf16 v[208:211], v[88:91], v[44:47], v[208:211]
    s_add_u32 m0, s3, 110592
    s_add_u32 s59, s27, 4096
    buffer_load_dwordx4 v2, s[12:15], s59 offen lds
    v_mfma_f32_16x16x32_bf16 v[212:215], v[88:91], v[48:51], v[212:215]
    s_waitcnt lgkmcnt(0)
    v_mfma_f32_16x16x32_bf16 v[192:195], v[76:79], v[52:55], v[192:195]
    s_add_u32 m0, s3, 65536
    s_add_u32 s59, s27, 8192
    buffer_load_dwordx4 v2, s[12:15], s59 offen lds
    v_mfma_f32_16x16x32_bf16 v[196:199], v[76:79], v[56:59], v[196:199]
    v_mfma_f32_16x16x32_bf16 v[200:203], v[76:79], v[60:63], v[200:203]
    s_cmp_eq_u32 s47, 0
    s_cbranch_scc1 L_slow_4
    buffer_store_dwordx4 v[240:243], v1, s[28:31], s32 offen offset:0
    buffer_store_dwordx4 v[240:243], v1, s[28:31], s32 offen offset:1024
    buffer_store_dwordx4 v[240:243], v1, s[28:31], s32 offen offset:2048
    s_mov_b64 exec, 0xffff
    buffer_store_dwordx4 v[240:243], v1, s[28:31], s32 offen offset:3072
    s_mov_b64 exec, -1
L_join_5:
    s_add_u32 m0, s3, 69632
    s_add_u32 s59, s27, 12288
    buffer_load_dwordx4 v2, s[12:15], s59 offen lds
    v_mfma_f32_16x16x32_bf16 v[204:207], v[92:95], v[52:55], v[204:207]
    v_mfma_f32_16x16x32_bf16 v[208:211], v[92:95], v[56:59], v[208:211]
    s_add_u32 m0, s3, 73728
    s_add_u32 s59, s4, 0
    buffer_load_dwordx4 v2, s[12:15], s59 offen lds
    v_mfma_f32_16x16x32_bf16 v[212:215], v[92:95], v[60:63], v[212:215]
    v_mfma_f32_16x16x32_bf16 v[64:67], v[96:99], v[16:19], 0
    s_add_u32 m0, s3, 77824
    s_add_u32 s59, s4, 4096
    buffer_load_dwordx4 v2, s[12:15], s59 offen lds
    v_mfma_f32_16x16x32_bf16 v[64:67], v[100:103], v[28:31], v[64:67]
    v_mfma_f32_16x16x32_bf16 v[64:67], v[104:107], v[40:43], v[64:67]
    s_add_u32 m0, s3, 81920
    s_add_u32 s59, s4, 8192
    buffer_load_dwordx4 v2, s[12:15], s59 offen lds
    v_mfma_f32_16x16x32_bf16 v[64:67], v[108:111], v[52:55], v[64:67]
    v_max3_f32 v232, v192, v193, v194
    v_mfma_f32_16x16x32_bf16 v[68:71], v[108:111], v[56:59], 0
    s_add_u32 m0, s3, 86016
    s_add_u32 s59, s4, 12288
    buffer_load_dwordx4 v2, s[12:15], s59 offen lds
    v_max_f32 v232, v232, v195
    v_mfma_f32_16x16x32_bf16 v[68:71], v[104:107], v[44:47], v[68:71]
    v_mfma_f32_16x16x32_bf16 v[68:71], v[100:103], v[32:35], v[68:71]
    s_add_u32 m0, s3, 32768
    s_add_u32 s59, s5, 0
    buffer_load_dwordx4 v2, s[12:15], s59 offen lds
    v_max3_f32 v233, v196, v197, v198
    v_mfma_f32_16x16x32_bf16 v[68:71], v[96:99], v[20:23], v[68:71]
    v_mfma_f32_16x16x32_bf16 v[72:75], v[96:99], v[24:27], 0
    s_add_u32 m0, s3, 36864
    s_add_u32 s59, s5, 4096
    buffer_load_dwordx4 v2, s[12:15], s59 offen lds
    v_max_f32 v233, v233, v199
    v_mfma_f32_16x16x32_bf16 v[72:75], v[100:103], v[36:39], v[72:75]
    v_mfma_f32_16x16x32_bf16 v[72:75], v[104:107], v[48:51], v[72:75]
    s_add_u32 m0, s3, 40960
    s_add_u32 s59, s5, 8192
    buffer_load_dwordx4 v2, s[12:15], s59 offen lds
    v_max3_f32 v234, v200, v201, v202
    v_mfma_f32_16x16x32_bf16 v[72:75], v[108:111], v[60:63], v[72:75]
    v_max_f32 v234, v234, v203
    v_mfma_f32_16x16x32_bf16 v[76:79], v[124:127], v[52:55], 0
    s_add_u32 m0, s3, 45056
    s_add_u32 s59, s5, 12288
    buffer_load_dwordx4 v2, s[12:15], s59 offen lds
    v_mfma_f32_16x16x32_bf16 v[76:79], v[120:123], v[40:43], v[76:79]
    v_max3_f32 v232, v232, v204, v205
    v_mfma_f32_16x16x32_bf16 v[76:79], v[116:119], v[28:31], v[76:79]
    v_mfma_f32_16x16x32_bf16 v[76:79], v[112:115], v[16:19], v[76:79]
    v_max3_f32 v232, v232, v206, v207
    v_mfma_f32_16x16x32_bf16 v[80:83], v[112:115], v[20:23], 0
    s_waitcnt vmcnt(9)
    buffer_store_byte v255, v254, s[28:31], s68 offen offset:12 sc1
    v_mfma_f32_16x16x32_bf16 v[80:83], v[116:119], v[32:35], v[80:83]
    v_max3_f32 v233, v233, v208, v209
    v_mfma_f32_16x16x32_bf16 v[80:83], v[120:123], v[44:47], v[80:83]
    buffer_load_dword v252, v11, s[20:23], s0 offen
    v_max3_f32 v233, v233, v210, v211
    v_mfma_f32_16x16x32_bf16 v[80:83], v[124:127], v[56:59], v[80:83]
    v_mfma_f32_16x16x32_bf16 v[84:87], v[124:127], v[60:63], 0
    v_max3_f32 v234, v234, v212, v213
    v_mfma_f32_16x16x32_bf16 v[84:87], v[120:123], v[48:51], v[84:87]
    v_mfma_f32_16x16x32_bf16 v[84:87], v[116:119], v[36:39], v[84:87]
    v_max3_f32 v234, v234, v214, v215
    v_mfma_f32_16x16x32_bf16 v[84:87], v[112:115], v[24:27], v[84:87]
    v_mfma_f32_16x16x32_bf16 v[96:99], v[128:131], v[16:19], 0
    v_mfma_f32_16x16x32_bf16 v[96:99], v[132:135], v[28:31], v[96:99]
    v_mfma_f32_16x16x32_bf16 v[96:99], v[136:139], v[40:43], v[96:99]
    v_mfma_f32_16x16x32_bf16 v[96:99], v[140:143], v[52:55], v[96:99]
    v_max3_f32 v232, v232, v64, v65
    v_mfma_f32_16x16x32_bf16 v[100:103], v[140:143], v[56:59], 0
    v_max3_f32 v232, v232, v66, v67
    v_mfma_f32_16x16x32_bf16 v[100:103], v[136:139], v[44:47], v[100:103]
    v_mfma_f32_16x16x32_bf16 v[100:103], v[132:135], v[32:35], v[100:103]
    v_max3_f32 v233, v233, v68, v69
    v_mfma_f32_16x16x32_bf16 v[100:103], v[128:131], v[20:23], v[100:103]
    v_mfma_f32_16x16x32_bf16 v[104:107], v[128:131], v[24:27], 0
    v_max3_f32 v233, v233, v70, v71
    v_mfma_f32_16x16x32_bf16 v[104:107], v[132:135], v[36:39], v[104:107]
    v_mfma_f32_16x16x32_bf16 v[104:107], v[136:139], v[48:51], v[104:107]
    v_max3_f32 v234, v234, v72, v73
    v_mfma_f32_16x16x32_bf16 v[104:107], v[140:143], v[60:63], v[104:107]
    v_max3_f32 v234, v234, v74, v75
    v_mfma_f32_16x16x32_bf16 v[108:111], v[156:159], v[52:55], 0
    v_mfma_f32_16x16x32_bf16 v[108:111], v[152:155], v[40:43], v[108:111]
    v_max3_f32 v232, v232, v76, v77
    v_mfma_f32_16x16x32_bf16 v[108:111], v[148:151], v[28:31], v[108:111]
    v_mfma_f32_16x16x32_bf16 v[108:111], v[144:147], v[16:19], v[108:111]
    v_max3_f32 v232, v232, v78, v79
    v_mfma_f32_16x16x32_bf16 v[112:115], v[144:147], v[20:23], 0
    v_mfma_f32_16x16x32_bf16 v[112:115], v[148:151], v[32:35], v[112:115]
    v_max3_f32 v233, v233, v80, v81
    v_mfma_f32_16x16x32_bf16 v[112:115], v[152:155], v[44:47], v[112:115]
    v_max3_f32 v233, v233, v82, v83
    v_mfma_f32_16x16x32_bf16 v[112:115], v[156:159], v[56:59], v[112:115]
    v_mfma_f32_16x16x32_bf16 v[116:119], v[156:159], v[60:63], 0
    v_max3_f32 v234, v234, v84, v85
    v_mfma_f32_16x16x32_bf16 v[116:119], v[152:155], v[48:51], v[116:119]
    v_mfma_f32_16x16x32_bf16 v[116:119], v[148:151], v[36:39], v[116:119]
    v_max3_f32 v234, v234, v86, v87
    v_mfma_f32_16x16x32_bf16 v[116:119], v[144:147], v[24:27], v[116:119]
    v_mfma_f32_16x16x32_bf16 v[128:131], v[160:163], v[16:19], 0
    v_mfma_f32_16x16x32_bf16 v[128:131], v[164:167], v[28:31], v[128:131]
    v_mfma_f32_16x16x32_bf16 v[128:131], v[168:171], v[40:43], v[128:131]
    v_max3_f32 v232, v232, v96, v97
    v_mfma_f32_16x16x32_bf16 v[128:131], v[172:175], v[52:55], v[128:131]
    v_max3_f32 v232, v232, v98, v99
    v_mfma_f32_16x16x32_bf16 v[132:135], v[172:175], v[56:59], 0
    v_max3_f32 v233, v233, v100, v101
    v_mfma_f32_16x16x32_bf16 v[132:135], v[168:171], v[44:47], v[132:135]
    v_max3_f32 v233, v233, v102, v103
    v_mfma_f32_16x16x32_bf16 v[132:135], v[164:167], v[32:35], v[132:135]
    v_max3_f32 v234, v234, v104, v105
    v_mfma_f32_16x16x32_bf16 v[132:135], v[160:163], v[20:23], v[132:135]
    v_max3_f32 v234, v234, v106, v107
    v_mfma_f32_16x16x32_bf16 v[136:139], v[160:163], v[24:27], 0
    v_max3_f32 v232, v232, v108, v109
    v_mfma_f32_16x16x32_bf16 v[136:139], v[164:167], v[36:39], v[136:139]
    v_max3_f32 v232, v232, v110, v111
    v_mfma_f32_16x16x32_bf16 v[136:139], v[168:171], v[48:51], v[136:139]
    v_max3_f32 v233, v233, v112, v113
    v_mfma_f32_16x16x32_bf16 v[136:139], v[172:175], v[60:63], v[136:139]
    v_max3_f32 v233, v233, v114, v115
    v_mfma_f32_16x16x32_bf16 v[140:143], v[188:191], v[52:55], 0
    v_max3_f32 v234, v234, v116, v117
    v_mfma_f32_16x16x32_bf16 v[140:143], v[184:187], v[40:43], v[140:143]
    v_max3_f32 v234, v234, v118, v119
    v_mfma_f32_16x16x32_bf16 v[140:143], v[180:183], v[28:31], v[140:143]
    v_mfma_f32_16x16x32_bf16 v[140:143], v[176:179], v[16:19], v[140:143]
    v_max3_f32 v232, v232, v128, v129
    v_mfma_f32_16x16x32_bf16 v[144:147], v[176:179], v[20:23], 0
    v_max3_f32 v232, v232, v130, v131
    v_mfma_f32_16x16x32_bf16 v[144:147], v[180:183], v[32:35], v[144:147]
    v_max3_f32 v233, v233, v132, v133
    v_mfma_f32_16x16x32_bf16 v[144:147], v[184:187], v[44:47], v[144:147]
    v_max3_f32 v233, v233, v134, v135
    v_mfma_f32_16x16x32_bf16 v[144:147], v[188:191], v[56:59], v[144:147]
    v_max3_f32 v234, v234, v136, v137
    v_mfma_f32_16x16x32_bf16 v[148:151], v[188:191], v[60:63], 0
    v_max3_f32 v234, v234, v138, v139
    v_mfma_f32_16x16x32_bf16 v[148:151], v[184:187], v[48:51], v[148:151]
    s_mul_i32 s56, s36, 3072
    v_mfma_f32_16x16x32_bf16 v[148:151], v[180:183], v[36:39], v[148:151]
    s_add_u32 s56, s56, 65536
    v_mfma_f32_16x16x32_bf16 v[148:151], v[176:179], v[24:27], v[148:151]
    v_add_u32 v15, s56, v1
    v_max3_f32 v232, v232, v140, v141
    v_max3_f32 v232, v232, v142, v143
    v_max3_f32 v233, v233, v144, v145
    v_max3_f32 v233, v233, v146, v147
    s_nop 2
    v_max3_f32 v234, v234, v148, v149
    v_max3_f32 v234, v234, v150, v151
    v_mov_b32 v238, v232
    v_mov_b32 v239, v233
    v_mov_b32 v240, v234
    v_permlane32_swap_b32 v232, v238
    v_permlane32_swap_b32 v233, v239
    v_permlane32_swap_b32 v234, v240
    v_max_f32 v232, v232, v238
    v_max_f32 v233, v233, v239
    v_max_f32 v234, v234, v240
    v_mov_b32 v238, v232
    v_mov_b32 v239, v233
    v_mov_b32 v240, v234
    v_permlane16_swap_b32 v232, v238
    v_permlane16_swap_b32 v233, v239
    v_permlane16_swap_b32 v234, v240
    v_max_f32 v232, v232, v238
    v_max_f32 v233, v233, v239
    v_max_f32 v234, v234, v240
    s_mov_b64 exec, 0xffff
    v_mov_b32 v234, v232
    s_mov_b32 exec_lo, 0xffff0000
    v_mov_b32 v234, v233
    s_mov_b64 exec, -1
    ds_write_b32 v250, v234 offset:768
    s_waitcnt vmcnt(6)
    s_waitcnt lgkmcnt(0)
    s_barrier
    s_setprio 1
    ds_read_b128 v[238:241], v251 offset:768
    ds_read_b128 v[242:245], v251 offset:1024
    ds_read_b128 v[246:249], v251 offset:1280
    v_mov_b32 v228, 0x3f803f80
    v_mov_b32 v229, 0x3f803f80
    v_mov_b32 v230, 0x3f803f80
    v_mov_b32 v231, 0x3f803f80
    s_waitcnt lgkmcnt(2)
    v_max3_f32 v238, v238, v239, v240
    v_max_f32 v238, v238, v241
    v_mul_f32 v235, s45, v238
    s_waitcnt lgkmcnt(1)
    v_max3_f32 v242, v242, v243, v244
    v_max_f32 v242, v242, v245
    v_mul_f32 v236, s45, v242
    s_waitcnt lgkmcnt(0)
    v_max3_f32 v246, v246, v247, v248
    v_max_f32 v246, v246, v249
    v_mul_f32 v237, s45, v246
    v_fma_f32 v96, v96, s45, -v235
    v_fma_f32 v97, v97, s45, -v235
    v_fma_f32 v98, v98, s45, -v235
    v_fma_f32 v99, v99, s45, -v235
    v_fma_f32 v108, v108, s45, -v235
    v_fma_f32 v109, v109, s45, -v235
    v_fma_f32 v110, v110, s45, -v235
    v_fma_f32 v111, v111, s45, -v235
    v_exp_f32 v96, v96
    v_exp_f32 v97, v97
    v_fma_f32 v100, v100, s45, -v236
    v_fma_f32 v101, v101, s45, -v236
    v_exp_f32 v98, v98
    v_exp_f32 v99, v99
    v_fma_f32 v102, v102, s45, -v236
    v_fma_f32 v103, v103, s45, -v236
    v_exp_f32 v108, v108
    v_exp_f32 v109, v109
    v_fma_f32 v112, v112, s45, -v236
    v_fma_f32 v113, v113, s45, -v236
    v_exp_f32 v110, v110
    v_exp_f32 v111, v111
    v_fma_f32 v114, v114, s45, -v236
    v_fma_f32 v115, v115, s45, -v236
    v_exp_f32 v100, v100
    v_exp_f32 v101, v101
    v_cvt_pk_bf16_f32 v96, v96, v97
    v_cvt_pk_bf16_f32 v97, v98, v99
    v_cvt_pk_bf16_f32 v98, v108, v109
    v_exp_f32 v102, v102
    v_exp_f32 v103, v103
    v_cvt_pk_bf16_f32 v99, v110, v111
    v_fma_f32 v104, v104, s45, -v237
    v_fma_f32 v105, v105, s45, -v237
    v_exp_f32 v112, v112
    v_exp_f32 v113, v113
    v_fma_f32 v106, v106, s45, -v237
    v_fma_f32 v107, v107, s45, -v237
    v_fma_f32 v116, v116, s45, -v237
    v_exp_f32 v114, v114
    v_exp_f32 v115, v115
    v_fma_f32 v117, v117, s45, -v237
    v_fma_f32 v118, v118, s45, -v237
    v_fma_f32 v119, v119, s45, -v237
    s_waitcnt vmcnt(2)
    s_barrier
    v_exp_f32 v104, v104
    v_exp_f32 v105, v105
    v_mfma_f32_16x16x32_bf16 v[216:219], v[228:231], v[96:99], 0
    v_cvt_pk_bf16_f32 v100, v100, v101
    v_cvt_pk_bf16_f32 v101, v102, v103
    v_cvt_pk_bf16_f32 v102, v112, v113
    v_exp_f32 v106, v106
    v_exp_f32 v107, v107
    v_cvt_pk_bf16_f32 v103, v114, v115
    v_fma_f32 v64, v64, s45, -v235
    v_fma_f32 v65, v65, s45, -v235
    v_exp_f32 v116, v116
    v_exp_f32 v117, v117
    v_fma_f32 v66, v66, s45, -v235
    v_fma_f32 v67, v67, s45, -v235
    v_fma_f32 v76, v76, s45, -v235
    v_exp_f32 v118, v118
    v_exp_f32 v119, v119
    v_fma_f32 v77, v77, s45, -v235
    v_fma_f32 v78, v78, s45, -v235
    v_fma_f32 v79, v79, s45, -v235
    v_exp_f32 v64, v64
    v_exp_f32 v65, v65
    v_mfma_f32_16x16x32_bf16 v[220:223], v[228:231], v[100:103], 0
    v_cvt_pk_bf16_f32 v104, v104, v105
    v_cvt_pk_bf16_f32 v105, v106, v107
    v_cvt_pk_bf16_f32 v106, v116, v117
    v_exp_f32 v66, v66
    v_exp_f32 v67, v67
    v_cvt_pk_bf16_f32 v107, v118, v119
    v_fma_f32 v68, v68, s45, -v236
    v_fma_f32 v69, v69, s45, -v236
    v_exp_f32 v76, v76
    v_exp_f32 v77, v77
    v_fma_f32 v70, v70, s45, -v236
    v_fma_f32 v71, v71, s45, -v236
    v_fma_f32 v80, v80, s45, -v236
    v_exp_f32 v78, v78
    v_exp_f32 v79, v79
    v_fma_f32 v81, v81, s45, -v236
    v_fma_f32 v82, v82, s45, -v236
    v_fma_f32 v83, v83, s45, -v236
    v_exp_f32 v68, v68
    v_exp_f32 v69, v69
    v_mfma_f32_16x16x32_bf16 v[224:227], v[228:231], v[104:107], 0
    v_cvt_pk_bf16_f32 v64, v64, v65
    v_cvt_pk_bf16_f32 v65, v66, v67
    v_cvt_pk_bf16_f32 v66, v76, v77
    v_exp_f32 v70, v70
    v_exp_f32 v71, v71
    v_cvt_pk_bf16_f32 v67, v78, v79
    v_fma_f32 v72, v72, s45, -v237
    v_fma_f32 v73, v73, s45, -v237
    v_exp_f32 v80, v80
    v_exp_f32 v81, v81
    v_fma_f32 v74, v74, s45, -v237
    v_fma_f32 v75, v75, s45, -v237
    v_fma_f32 v84, v84, s45, -v237
    v_exp_f32 v82, v82
    v_exp_f32 v83, v83
    v_fma_f32 v85, v85, s45, -v237
    v_fma_f32 v86, v86, s45, -v237
    v_fma_f32 v87, v87, s45, -v237
    v_exp_f32 v72, v72
    v_exp_f32 v73, v73
    v_mfma_f32_16x16x32_bf16 v[216:219], v[228:231], v[64:67], v[216:219]
    v_cvt_pk_bf16_f32 v68, v68, v69
    v_cvt_pk_bf16_f32 v69, v70, v71
    v_cvt_pk_bf16_f32 v70, v80, v81
    v_exp_f32 v74, v74
    v_exp_f32 v75, v75
    v_cvt_pk_bf16_f32 v71, v82, v83
    v_fma_f32 v128, v128, s45, -v235
    v_fma_f32 v129, v129, s45, -v235
    v_exp_f32 v84, v84
    v_exp_f32 v85, v85
    v_fma_f32 v130, v130, s45, -v235
    v_fma_f32 v131, v131, s45, -v235
    v_fma_f32 v140, v140, s45, -v235
    v_exp_f32 v86, v86
    v_exp_f32 v87, v87
    v_fma_f32 v141, v141, s45, -v235
    v_fma_f32 v142, v142, s45, -v235
    v_fma_f32 v143, v143, s45, -v235
    v_exp_f32 v128, v128
    v_exp_f32 v129, v129
    v_mfma_f32_16x16x32_bf16 v[220:223], v[228:231], v[68:71], v[220:223]
    v_cvt_pk_bf16_f32 v72, v72, v73
    v_cvt_pk_bf16_f32 v73, v74, v75
    v_cvt_pk_bf16_f32 v74, v84, v85
    v_exp_f32 v130, v130
    v_exp_f32 v131, v131
    v_cvt_pk_bf16_f32 v75, v86, v87
    v_fma_f32 v132, v132, s45, -v236
    v_fma_f32 v133, v133, s45, -v236
    v_exp_f32 v140, v140
    v_exp_f32 v141, v141
    v_fma_f32 v134, v134, s45, -v236
    v_fma_f32 v135, v135, s45, -v236
    v_fma_f32 v144, v144, s45, -v236
    v_exp_f32 v142, v142
    v_exp_f32 v143, v143
    v_fma_f32 v145, v145, s45, -v236
    v_fma_f32 v146, v146, s45, -v236
    v_fma_f32 v147, v147, s45, -v236
    v_exp_f32 v132, v132
    v_exp_f32 v133, v133
    ds_write_b128 v15, v[96:99] offset:24576
    v_mfma_f32_16x16x32_bf16 v[224:227], v[228:231], v[72:75], v[224:227]
    v_cvt_pk_bf16_f32 v128, v128, v129
    v_cvt_pk_bf16_f32 v129, v130, v131
    s_load_dword s60, s[34:35], 12 glc
    v_exp_f32 v134, v134
    v_exp_f32 v135, v135
    v_cvt_pk_bf16_f32 v130, v140, v141
    v_cvt_pk_bf16_f32 v131, v142, v143
    v_fma_f32 v136, v136, s45, -v237
    v_fma_f32 v137, v137, s45, -v237
    v_exp_f32 v144, v144
    v_exp_f32 v145, v145
    v_fma_f32 v138, v138, s45, -v237
    ds_write_b128 v15, v[100:103] offset:25600
    v_fma_f32 v139, v139, s45, -v237
    v_fma_f32 v148, v148, s45, -v237
    v_exp_f32 v146, v146
    v_exp_f32 v147, v147
    v_fma_f32 v149, v149, s45, -v237
    v_fma_f32 v150, v150, s45, -v237
    v_fma_f32 v151, v151, s45, -v237
    v_exp_f32 v136, v136
    v_exp_f32 v137, v137
    ds_write_b128 v15, v[104:107] offset:26624
    v_mfma_f32_16x16x32_bf16 v[216:219], v[228:231], v[128:131], v[216:219]
    v_cvt_pk_bf16_f32 v132, v132, v133
    v_cvt_pk_bf16_f32 v133, v134, v135
    v_exp_f32 v138, v138
    v_exp_f32 v139, v139
    v_cvt_pk_bf16_f32 v134, v144, v145
    v_cvt_pk_bf16_f32 v135, v146, v147
    v_fma_f32 v192, v192, s45, -v235
    v_fma_f32 v193, v193, s45, -v235
    v_exp_f32 v148, v148
    v_exp_f32 v149, v149
    v_fma_f32 v194, v194, s45, -v235
    ds_write_b128 v15, v[64:67] offset:12288
    v_fma_f32 v195, v195, s45, -v235
    v_fma_f32 v204, v204, s45, -v235
    v_exp_f32 v150, v150
    v_exp_f32 v151, v151
    v_fma_f32 v205, v205, s45, -v235
    v_fma_f32 v206, v206, s45, -v235
    v_fma_f32 v207, v207, s45, -v235
    s_barrier
    v_exp_f32 v192, v192
    v_exp_f32 v193, v193
    ds_write_b128 v15, v[68:71] offset:13312
    v_mfma_f32_16x16x32_bf16 v[220:223], v[228:231], v[132:135], v[220:223]
    v_cvt_pk_bf16_f32 v136, v136, v137
    v_cvt_pk_bf16_f32 v137, v138, v139
    v_exp_f32 v194, v194
    v_exp_f32 v195, v195
    v_cvt_pk_bf16_f32 v138, v148, v149
    v_cvt_pk_bf16_f32 v139, v150, v151
    v_fma_f32 v196, v196, s45, -v236
    v_fma_f32 v197, v197, s45, -v236
    v_exp_f32 v204, v204
    v_exp_f32 v205, v205
    v_fma_f32 v198, v198, s45, -v236
    ds_write_b128 v15, v[72:75] offset:14336
    v_fma_f32 v199, v199, s45, -v236
    v_fma_f32 v208, v208, s45, -v236
    v_exp_f32 v206, v206
    v_exp_f32 v207, v207
    v_fma_f32 v209, v209, s45, -v236
    v_fma_f32 v210, v210, s45, -v236
    v_fma_f32 v211, v211, s45, -v236
    v_exp_f32 v196, v196
    v_exp_f32 v197, v197
    ds_write_b128 v15, v[128:131] offset:36864
    v_mfma_f32_16x16x32_bf16 v[224:227], v[228:231], v[136:139], v[224:227]
    v_cvt_pk_bf16_f32 v192, v192, v193
    v_cvt_pk_bf16_f32 v193, v194, v195
    v_exp_f32 v198, v198
    v_exp_f32 v199, v199
    v_cvt_pk_bf16_f32 v194, v204, v205
    v_cvt_pk_bf16_f32 v195, v206, v207
    v_fma_f32 v200, v200, s45, -v237
    v_fma_f32 v201, v201, s45, -v237
    v_exp_f32 v208, v208
    v_exp_f32 v209, v209
    v_fma_f32 v202, v202, s45, -v237
    ds_write_b128 v15, v[132:135] offset:37888
    v_fma_f32 v203, v203, s45, -v237
    v_fma_f32 v212, v212, s45, -v237
    v_exp_f32 v210, v210
    v_exp_f32 v211, v211
    v_fma_f32 v213, v213, s45, -v237
    v_fma_f32 v214, v214, s45, -v237
    v_fma_f32 v215, v215, s45, -v237
    v_exp_f32 v200, v200
    v_exp_f32 v201, v201
    ds_write_b128 v15, v[136:139] offset:38912
    v_mfma_f32_16x16x32_bf16 v[216:219], v[228:231], v[192:195], v[216:219]
    v_exp_f32 v202, v202
    v_exp_f32 v203, v203
    v_cvt_pk_bf16_f32 v196, v196, v197
    v_cvt_pk_bf16_f32 v197, v198, v199
    v_exp_f32 v212, v212
    v_exp_f32 v213, v213
    v_cvt_pk_bf16_f32 v198, v208, v209
    v_cvt_pk_bf16_f32 v199, v210, v211
    v_exp_f32 v214, v214
    v_exp_f32 v215, v215
    ds_write_b128 v15, v[192:195] offset:0
    ds_write_b128 v15, v[196:199] offset:1024
    v_mfma_f32_16x16x32_bf16 v[220:223], v[228:231], v[196:199], v[220:223]
    v_cvt_pk_bf16_f32 v200, v200, v201
    v_cvt_pk_bf16_f32 v201, v202, v203
    v_cvt_pk_bf16_f32 v202, v212, v213
    v_cvt_pk_bf16_f32 v203, v214, v215
    ds_write_b128 v15, v[200:203] offset:2048
    s_nop 0
    v_mfma_f32_16x16x32_bf16 v[224:227], v[228:231], v[200:203], v[224:227]
    s_mov_b64 exec, 0xffff
    s_nop 6
    v_mov_b32 v224, v216
    s_mov_b32 exec_lo, 0xffff0000
    v_mov_b32 v224, v220
    s_mov_b64 exec, -1
    ds_write_b32 v250, v224 offset:2304
    s_setprio 0
    s_mov_b32 s46, 0
L_cfok_7:
    s_waitcnt lgkmcnt(0)
    s_cmp_eq_u32 s60, 0x01010101
    s_cbranch_scc0 L_cfpoll_6
    s_barrier
    s_add_u32 m0, s3, 32768
    s_add_u32 s59, s48, 0
    buffer_load_dwordx4 v3, s[20:23], s59 offen lds
    s_add_u32 m0, s3, 36864
    s_add_u32 s59, s48, 32768
    buffer_load_dwordx4 v3, s[20:23], s59 offen lds
    s_add_u32 m0, s3, 40960
    s_add_u32 s59, s48, 65536
    buffer_load_dwordx4 v3, s[20:23], s59 offen lds
    s_add_u32 m0, s3, 45056
    s_add_u32 s59, s48, 98304
    buffer_load_dwordx4 v3, s[20:23], s59 offen lds
    s_add_u32 m0, s3, 53248
    s_add_u32 s59, s48, 131072
    s_waitcnt vmcnt(5)
    buffer_load_dwordx4 v3, s[20:23], s59 offen lds
    s_add_u32 m0, s3, 57344
    s_add_u32 s59, s48, 163840
    s_waitcnt vmcnt(5)
    buffer_load_dwordx4 v3, s[20:23], s59 offen lds
    s_add_u32 m0, s3, 114688
    s_add_u32 s59, s48, 196608
    s_waitcnt vmcnt(5)
    buffer_load_dwordx4 v3, s[20:23], s59 offen lds
    s_add_u32 m0, s3, 118784
    s_add_u32 s59, s48, 229376
    s_waitcnt vmcnt(5)
    buffer_load_dwordx4 v3, s[20:23], s59 offen lds
    s_add_u32 m0, s3, 122880
    s_add_u32 s59, s49, 0
    s_waitcnt vmcnt(5)
    buffer_load_dwordx4 v3, s[20:23], s59 offen lds
    s_add_u32 m0, s3, 126976
    s_add_u32 s59, s49, 32768
    s_waitcnt vmcnt(5)
    buffer_load_dwordx4 v3, s[20:23], s59 offen lds
    s_add_u32 m0, s3, 131072
    s_add_u32 s59, s49, 65536
    s_waitcnt vmcnt(5)
    buffer_load_dwordx4 v3, s[20:23], s59 offen lds
    s_add_u32 m0, s3, 135168
    s_add_u32 s59, s49, 98304
    s_waitcnt vmcnt(5)
    buffer_load_dwordx4 v3, s[20:23], s59 offen lds
    v_mov_b32 v244, 1
    ds_write_b32 v250, v244 offset:3072
    s_add_u32 m0, s3, 139264
    s_add_u32 s59, s49, 131072
    s_waitcnt vmcnt(5)
    buffer_load_dwordx4 v3, s[20:23], s59 offen lds
    s_add_u32 m0, s3, 143360
    s_add_u32 s59, s49, 163840
    s_waitcnt vmcnt(5)
    buffer_load_dwordx4 v3, s[20:23], s59 offen lds
    s_add_u32 m0, s3, 0
    s_add_u32 s59, s49, 196608
    s_waitcnt vmcnt(5)
    buffer_load_dwordx4 v3, s[20:23], s59 offen lds
    s_add_u32 m0, s3, 4096
    s_add_u32 s59, s49, 229376
    s_waitcnt vmcnt(5)
    buffer_load_dwordx4 v3, s[20:23], s59 offen lds
    s_add_u32 m0, s3, 8192
    s_add_u32 s59, s50, 0
    s_waitcnt vmcnt(5)
    buffer_load_dwordx4 v3, s[20:23], s59 offen lds
    s_add_u32 m0, s3, 12288
    s_add_u32 s59, s50, 32768
    s_waitcnt vmcnt(5)
    buffer_load_dwordx4 v3, s[20:23], s59 offen lds
    s_mov_b32 s46, 0
L_lw_8:
    s_add_u32 s46, s46, 1
    s_cmp_gt_u32 s46, 1048576
    s_cbranch_scc1 L_end
    ds_read_b128 v[240:243], v251 offset:3072
    s_waitcnt lgkmcnt(0)
    v_and_b32 v240, v240, v241
    v_and_b32 v242, v242, v243
    v_and_b32 v240, v240, v242
    s_nop 0
    v_readfirstlane_b32 s56, v240
    s_bitcmp1_b32 s56, 0
    s_cbranch_scc0 L_lw_8
    ds_read_b64_tr_b16 v[64:65], v7 offset:32768
    ds_read_b64_tr_b16 v[66:67], v7 offset:36864
    ds_read_b64_tr_b16 v[68:69], v8 offset:32768
    ds_read_b64_tr_b16 v[70:71], v8 offset:36864
    ds_read_b64_tr_b16 v[72:73], v7 offset:40960
    ds_read_b64_tr_b16 v[74:75], v7 offset:45056
    ds_read_b64_tr_b16 v[76:77], v8 offset:40960
    ds_read_b64_tr_b16 v[78:79], v8 offset:45056
    ds_read_b64_tr_b16 v[80:81], v7 offset:53248
    ds_read_b64_tr_b16 v[82:83], v7 offset:57344
    ds_read_b64_tr_b16 v[84:85], v8 offset:53248
    ds_read_b64_tr_b16 v[86:87], v8 offset:57344
    s_add_u32 m0, s3, 16384
    s_add_u32 s59, s50, 65536
    s_waitcnt vmcnt(5)
    buffer_load_dwordx4 v3, s[20:23], s59 offen lds
    s_add_u32 m0, s3, 20480
    s_add_u32 s59, s50, 98304
    s_waitcnt vmcnt(5)
    buffer_load_dwordx4 v3, s[20:23], s59 offen lds
    s_waitcnt lgkmcnt(0)
    v_mov_b32 v244, 3
    ds_write_b32 v250, v244 offset:3072
    s_add_u32 m0, s3, 24576
    s_add_u32 s59, s50, 131072
    s_waitcnt vmcnt(5)
    buffer_load_dwordx4 v3, s[20:23], s59 offen lds
    s_add_u32 m0, s3, 28672
    s_add_u32 s59, s50, 163840
    s_waitcnt vmcnt(5)
    buffer_load_dwordx4 v3, s[20:23], s59 offen lds
    s_add_u32 m0, s3, 147456
    s_add_u32 s59, s50, 196608
    s_waitcnt vmcnt(5)
    buffer_load_dwordx4 v3, s[20:23], s59 offen lds
    s_add_u32 m0, s3, 151552
    s_add_u32 s59, s50, 229376
    s_waitcnt vmcnt(5)
    buffer_load_dwordx4 v3, s[20:23], s59 offen lds
    s_add_u32 m0, s3, 155648
    s_add_u32 s59, s51, 0
    s_waitcnt vmcnt(5)
    buffer_load_dwordx4 v3, s[20:23], s59 offen lds
    s_add_u32 m0, s3, 159744
    s_add_u32 s59, s51, 32768
    s_waitcnt vmcnt(5)
    buffer_load_dwordx4 v3, s[20:23], s59 offen lds
    s_mov_b32 s46, 0
L_lw_9:
    s_add_u32 s46, s46, 1
    s_cmp_gt_u32 s46, 1048576
    s_cbranch_scc1 L_end
    ds_read_b128 v[240:243], v251 offset:3072
    s_waitcnt lgkmcnt(0)
    v_and_b32 v240, v240, v241
    v_and_b32 v242, v242, v243
    v_and_b32 v240, v240, v242
    s_nop 0
    v_readfirstlane_b32 s56, v240
    s_bitcmp1_b32 s56, 1
    s_cbranch_scc0 L_lw_9
    s_add_u32 m0, s3, 32768
    s_add_u32 s59, s51, 65536
    s_waitcnt vmcnt(5)
    buffer_load_dwordx4 v3, s[20:23], s59 offen lds
    s_add_u32 m0, s3, 36864
    s_add_u32 s59, s51, 98304
    s_waitcnt vmcnt(5)
    buffer_load_dwordx4 v3, s[20:23], s59 offen lds
    ds_read_b64_tr_b16 v[88:89], v9 offset:0
    ds_read_b64_tr_b16 v[90:91], v9 offset:4096
    ds_read_b64_tr_b16 v[92:93], v10 offset:0
    ds_read_b64_tr_b16 v[94:95], v10 offset:4096
    ds_read_b64_tr_b16 v[96:97], v9 offset:8192
    ds_read_b64_tr_b16 v[98:99], v9 offset:12288
    ds_read_b64_tr_b16 v[100:101], v10 offset:8192
    ds_read_b64_tr_b16 v[102:103], v10 offset:12288
    ds_read_b64_tr_b16 v[104:105], v9 offset:16384
    ds_read_b64_tr_b16 v[106:107], v9 offset:20480
    ds_read_b64_tr_b16 v[108:109], v10 offset:16384
    ds_read_b64_tr_b16 v[110:111], v10 offset:20480
    s_waitcnt lgkmcnt(8)
    ds_read_b64_tr_b16 v[112:113], v9 offset:24576
    ds_read_b64_tr_b16 v[114:115], v9 offset:28672
    ds_read_b64_tr_b16 v[116:117], v10 offset:24576
    ds_read_b64_tr_b16 v[118:119], v10 offset:28672
    s_add_u32 m0, s3, 40960
    s_add_u32 s59, s51, 131072
    s_waitcnt vmcnt(5)
    buffer_load_dwordx4 v3, s[20:23], s59 offen lds
    s_add_u32 m0, s3, 45056
    s_add_u32 s59, s51, 163840
    s_waitcnt vmcnt(5)
    buffer_load_dwordx4 v3, s[20:23], s59 offen lds
    s_add_u32 m0, s3, 53248
    s_add_u32 s59, s51, 196608
    s_waitcnt vmcnt(5)
    buffer_load_dwordx4 v3, s[20:23], s59 offen lds
    s_add_u32 m0, s3, 57344
    s_add_u32 s59, s51, 229376
    s_waitcnt vmcnt(5)
    buffer_load_dwordx4 v3, s[20:23], s59 offen lds
    v_mov_b32 v244, 7
    ds_write_b32 v250, v244 offset:3072
    s_mov_b32 s46, 0
L_lw_10:
    s_add_u32 s46, s46, 1
    s_cmp_gt_u32 s46, 1048576
    s_cbranch_scc1 L_end
    ds_read_b128 v[240:243], v251 offset:3072
    s_waitcnt lgkmcnt(0)
    v_and_b32 v240, v240, v241
    v_and_b32 v242, v242, v243
    v_and_b32 v240, v240, v242
    s_nop 0
    v_readfirstlane_b32 s56, v240
    s_bitcmp1_b32 s56, 2
    s_cbranch_scc0 L_lw_10
    ds_read_b64_tr_b16 v[120:121], v7 offset:0
    ds_read_b64_tr_b16 v[122:123], v7 offset:4096
    ds_read_b64_tr_b16 v[124:125], v8 offset:0
    ds_read_b64_tr_b16 v[126:127], v8 offset:4096
    ds_read_b64_tr_b16 v[128:129], v7 offset:8192
    ds_read_b64_tr_b16 v[130:131], v7 offset:12288
    ds_read_b64_tr_b16 v[132:133], v8 offset:8192
    ds_read_b64_tr_b16 v[134:135], v8 offset:12288
    ds_read_b64_tr_b16 v[136:137], v7 offset:16384
    ds_read_b64_tr_b16 v[138:139], v7 offset:20480
    ds_read_b64_tr_b16 v[140:141], v8 offset:16384
    ds_read_b64_tr_b16 v[142:143], v8 offset:20480
    s_waitcnt lgkmcnt(8)
    ds_read_b64_tr_b16 v[144:145], v7 offset:24576
    ds_read_b64_tr_b16 v[146:147], v7 offset:28672
    ds_read_b64_tr_b16 v[148:149], v8 offset:24576
    ds_read_b64_tr_b16 v[150:151], v8 offset:28672
    s_waitcnt lgkmcnt(8)
    ds_read_b64_tr_b16 v[152:153], v9 offset:32768
    ds_read_b64_tr_b16 v[154:155], v9 offset:36864
    ds_read_b64_tr_b16 v[156:157], v10 offset:32768
    ds_read_b64_tr_b16 v[158:159], v10 offset:36864
    s_waitcnt lgkmcnt(8)
    ds_read_b64_tr_b16 v[160:161], v9 offset:40960
    ds_read_b64_tr_b16 v[162:163], v9 offset:45056
    ds_read_b64_tr_b16 v[164:165], v10 offset:40960
    ds_read_b64_tr_b16 v[166:167], v10 offset:45056
    v_add_u32 v11, 65536, v1
    v_add_u32 v12, 114688, v1
    s_lshl2_add_u32 s56, s41, s36
    s_lshl3_add_u32 s56, s56, s40
    s_mul_i32 s58, s37, 3072
    s_add_u32 s58, s58, 8388608
    s_mul_i32 s48, s56, 24576
    s_add_u32 s48, s48, s58
    s_xor_b32 s56, s56, 32
    s_mul_i32 s49, s56, 24576
    s_add_u32 s49, s49, s58
    s_add_u32 s49, s49, 12288
    s_lshl_b32 s50, s56, 7
    s_add_u32 s50, s50, s37
    s_andn2_b32 s56, s50, 3
    s_add_u32 s34, s28, s56
    s_addc_u32 s35, s29, 0
    s_lshl_b32 s56, s50, 3
    s_lshl_b32 s33, 1, s56
    s_waitcnt vmcnt(0) lgkmcnt(0)
    s_barrier
    ds_read_b128 v[192:195], v11 offset:0
    ds_read_b128 v[196:199], v11 offset:1024
    ds_read_b128 v[200:203], v11 offset:2048
    ds_read_b128 v[204:207], v11 offset:3072
    ds_read_b128 v[208:211], v11 offset:4096
    ds_read_b128 v[212:215], v11 offset:5120
    s_waitcnt lgkmcnt(0)
    v_mfma_f32_16x16x32_bf16 v[16:19], v[64:67], v[192:195], 0
    ds_read_b128 v[216:219], v11 offset:6144
    ds_read_b128 v[220:223], v11 offset:7168
    v_mfma_f32_16x16x32_bf16 v[16:19], v[72:75], v[204:207], v[16:19]
    ds_read_b128 v[224:227], v11 offset:8192
    ds_read_b128 v[228:231], v11 offset:9216
    v_mfma_f32_16x16x32_bf16 v[20:23], v[72:75], v[208:211], 0
    ds_read_b128 v[232:235], v11 offset:10240
    ds_read_b128 v[236:239], v11 offset:11264
    v_mfma_f32_16x16x32_bf16 v[20:23], v[64:67], v[196:199], v[20:23]
    ds_read_b64_tr_b16 v[168:169], v7 offset:32768
    ds_read_b64_tr_b16 v[170:171], v7 offset:36864
    v_mfma_f32_16x16x32_bf16 v[24:27], v[64:67], v[200:203], 0
    ds_read_b64_tr_b16 v[172:173], v8 offset:32768
    ds_read_b64_tr_b16 v[174:175], v8 offset:36864
    v_mfma_f32_16x16x32_bf16 v[24:27], v[72:75], v[212:215], v[24:27]
    ds_read_b64_tr_b16 v[176:177], v7 offset:40960
    ds_read_b64_tr_b16 v[178:179], v7 offset:45056
    v_mfma_f32_16x16x32_bf16 v[28:31], v[76:79], v[204:207], 0
    ds_read_b64_tr_b16 v[180:181], v8 offset:40960
    ds_read_b64_tr_b16 v[182:183], v8 offset:45056
    v_mfma_f32_16x16x32_bf16 v[28:31], v[68:71], v[192:195], v[28:31]
    v_mfma_f32_16x16x32_bf16 v[32:35], v[68:71], v[196:199], 0
    v_mfma_f32_16x16x32_bf16 v[32:35], v[76:79], v[208:211], v[32:35]
    v_mfma_f32_16x16x32_bf16 v[36:39], v[76:79], v[212:215], 0
    v_mfma_f32_16x16x32_bf16 v[36:39], v[68:71], v[200:203], v[36:39]
    s_waitcnt lgkmcnt(8)
    v_mfma_f32_16x16x32_bf16 v[16:19], v[80:83], v[216:219], v[16:19]
    v_mfma_f32_16x16x32_bf16 v[16:19], v[88:91], v[228:231], v[16:19]
    v_mfma_f32_16x16x32_bf16 v[20:23], v[88:91], v[232:235], v[20:23]
    s_barrier
    v_mfma_f32_16x16x32_bf16 v[20:23], v[80:83], v[220:223], v[20:23]
    ds_read_b128 v[192:195], v11 offset:12288
    ds_read_b128 v[196:199], v11 offset:13312
    v_mfma_f32_16x16x32_bf16 v[24:27], v[80:83], v[224:227], v[24:27]
    ds_read_b128 v[200:203], v11 offset:14336
    ds_read_b128 v[204:207], v11 offset:15360
    v_mfma_f32_16x16x32_bf16 v[24:27], v[88:91], v[236:239], v[24:27]
    ds_read_b128 v[208:211], v11 offset:16384
    ds_read_b128 v[212:215], v11 offset:17408
    v_mfma_f32_16x16x32_bf16 v[28:31], v[92:95], v[228:231], v[28:31]
    v_mfma_f32_16x16x32_bf16 v[28:31], v[84:87], v[216:219], v[28:31]
    v_mfma_f32_16x16x32_bf16 v[32:35], v[84:87], v[220:223], v[32:35]
    v_mfma_f32_16x16x32_bf16 v[32:35], v[92:95], v[232:235], v[32:35]
    v_mfma_f32_16x16x32_bf16 v[36:39], v[92:95], v[236:239], v[36:39]
    v_mfma_f32_16x16x32_bf16 v[36:39], v[84:87], v[224:227], v[36:39]
    s_waitcnt lgkmcnt(0)
    v_mfma_f32_16x16x32_bf16 v[16:19], v[96:99], v[192:195], v[16:19]
    ds_read_b128 v[216:219], v11 offset:18432
    ds_read_b128 v[220:223], v11 offset:19456
    v_mfma_f32_16x16x32_bf16 v[16:19], v[104:107], v[204:207], v[16:19]
    ds_read_b128 v[224:227], v11 offset:20480
    ds_read_b128 v[228:231], v11 offset:21504
    v_mfma_f32_16x16x32_bf16 v[20:23], v[104:107], v[208:211], v[20:23]
    ds_read_b128 v[232:235], v11 offset:22528
    ds_read_b128 v[236:239], v11 offset:23552
    v_mfma_f32_16x16x32_bf16 v[20:23], v[96:99], v[196:199], v[20:23]
    ds_read_b64_tr_b16 v[184:185], v7 offset:53248
    ds_read_b64_tr_b16 v[186:187], v7 offset:57344
    v_mfma_f32_16x16x32_bf16 v[24:27], v[96:99], v[200:203], v[24:27]
    ds_read_b64_tr_b16 v[188:189], v8 offset:53248
    ds_read_b64_tr_b16 v[190:191], v8 offset:57344
    v_mfma_f32_16x16x32_bf16 v[24:27], v[104:107], v[212:215], v[24:27]
    v_mfma_f32_16x16x32_bf16 v[28:31], v[108:111], v[204:207], v[28:31]
    v_mfma_f32_16x16x32_bf16 v[28:31], v[100:103], v[192:195], v[28:31]
    v_mfma_f32_16x16x32_bf16 v[32:35], v[100:103], v[196:199], v[32:35]
    v_mfma_f32_16x16x32_bf16 v[32:35], v[108:111], v[208:211], v[32:35]
    v_mfma_f32_16x16x32_bf16 v[36:39], v[108:111], v[212:215], v[36:39]
    v_mfma_f32_16x16x32_bf16 v[36:39], v[100:103], v[200:203], v[36:39]
    s_waitcnt lgkmcnt(4)
    v_mfma_f32_16x16x32_bf16 v[16:19], v[112:115], v[216:219], v[16:19]
    ds_read_b128 v[192:195], v11 offset:24576
    ds_read_b128 v[196:199], v11 offset:25600
    v_mfma_f32_16x16x32_bf16 v[16:19], v[120:123], v[228:231], v[16:19]
    ds_read_b128 v[200:203], v11 offset:26624
    ds_read_b128 v[204:207], v11 offset:27648
    v_mfma_f32_16x16x32_bf16 v[20:23], v[120:123], v[232:235], v[20:23]
    ds_read_b128 v[208:211], v11 offset:28672
    ds_read_b128 v[212:215], v11 offset:29696
    v_mfma_f32_16x16x32_bf16 v[20:23], v[112:115], v[220:223], v[20:23]
    v_mfma_f32_16x16x32_bf16 v[24:27], v[112:115], v[224:227], v[24:27]
    v_mfma_f32_16x16x32_bf16 v[24:27], v[120:123], v[236:239], v[24:27]
    v_mfma_f32_16x16x32_bf16 v[28:31], v[124:127], v[228:231], v[28:31]
    v_mfma_f32_16x16x32_bf16 v[28:31], v[116:119], v[216:219], v[28:31]
    v_mfma_f32_16x16x32_bf16 v[32:35], v[116:119], v[220:223], v[32:35]
    v_mfma_f32_16x16x32_bf16 v[32:35], v[124:127], v[232:235], v[32:35]
    v_mfma_f32_16x16x32_bf16 v[36:39], v[124:127], v[236:239], v[36:39]
    v_mfma_f32_16x16x32_bf16 v[36:39], v[116:119], v[224:227], v[36:39]
    s_waitcnt lgkmcnt(0)
    v_mfma_f32_16x16x32_bf16 v[16:19], v[128:131], v[192:195], v[16:19]
    ds_read_b128 v[216:219], v11 offset:30720
    ds_read_b128 v[220:223], v11 offset:31744
    v_mfma_f32_16x16x32_bf16 v[16:19], v[136:139], v[204:207], v[16:19]
    ds_read_b128 v[224:227], v11 offset:32768
    ds_read_b128 v[228:231], v11 offset:33792
    v_mfma_f32_16x16x32_bf16 v[20:23], v[136:139], v[208:211], v[20:23]
    ds_read_b128 v[232:235], v11 offset:34816
    ds_read_b128 v[236:239], v11 offset:35840
    v_mfma_f32_16x16x32_bf16 v[20:23], v[128:131], v[196:199], v[20:23]
    v_mfma_f32_16x16x32_bf16 v[24:27], v[128:131], v[200:203], v[24:27]
    v_mfma_f32_16x16x32_bf16 v[24:27], v[136:139], v[212:215], v[24:27]
    v_mfma_f32_16x16x32_bf16 v[28:31], v[140:143], v[204:207], v[28:31]
    v_mfma_f32_16x16x32_bf16 v[28:31], v[132:135], v[192:195], v[28:31]
    v_mfma_f32_16x16x32_bf16 v[32:35], v[132:135], v[196:199], v[32:35]
    v_mfma_f32_16x16x32_bf16 v[32:35], v[140:143], v[208:211], v[32:35]
    v_mfma_f32_16x16x32_bf16 v[36:39], v[140:143], v[212:215], v[36:39]
    v_mfma_f32_16x16x32_bf16 v[36:39], v[132:135], v[200:203], v[36:39]
    s_waitcnt lgkmcnt(0)
    v_mfma_f32_16x16x32_bf16 v[16:19], v[144:147], v[216:219], v[16:19]
    v_mfma_f32_16x16x32_bf16 v[16:19], v[152:155], v[228:231], v[16:19]
    v_mfma_f32_16x16x32_bf16 v[20:23], v[152:155], v[232:235], v[20:23]
    s_barrier
    v_mfma_f32_16x16x32_bf16 v[20:23], v[144:147], v[220:223], v[20:23]
    ds_read_b128 v[192:195], v11 offset:36864
    ds_read_b128 v[196:199], v11 offset:37888
    v_mfma_f32_16x16x32_bf16 v[24:27], v[144:147], v[224:227], v[24:27]
    ds_read_b128 v[200:203], v11 offset:38912
    ds_read_b128 v[204:207], v11 offset:39936
    v_mfma_f32_16x16x32_bf16 v[24:27], v[152:155], v[236:239], v[24:27]
    ds_read_b128 v[208:211], v11 offset:40960
    ds_read_b128 v[212:215], v11 offset:41984
    v_mfma_f32_16x16x32_bf16 v[28:31], v[156:159], v[228:231], v[28:31]
    s_or_b32 s56, s40, s39
    s_or_b32 s56, s56, s36
    s_cbranch_scc1 L_nowb_11
    buffer_wbl2 sc1
L_nowb_11:
    v_mfma_f32_16x16x32_bf16 v[28:31], v[148:151], v[216:219], v[28:31]
    v_mfma_f32_16x16x32_bf16 v[32:35], v[148:151], v[220:223], v[32:35]
    v_mfma_f32_16x16x32_bf16 v[32:35], v[156:159], v[232:235], v[32:35]
    v_mfma_f32_16x16x32_bf16 v[36:39], v[156:159], v[236:239], v[36:39]
    v_mfma_f32_16x16x32_bf16 v[36:39], v[148:151], v[224:227], v[36:39]
    s_waitcnt lgkmcnt(0)
    v_mfma_f32_16x16x32_bf16 v[16:19], v[160:163], v[192:195], v[16:19]
    ds_read_b128 v[216:219], v11 offset:43008
    ds_read_b128 v[220:223], v11 offset:44032
    v_mfma_f32_16x16x32_bf16 v[16:19], v[168:171], v[204:207], v[16:19]
    ds_read_b128 v[224:227], v11 offset:45056
    ds_read_b128 v[228:231], v11 offset:46080
    v_mfma_f32_16x16x32_bf16 v[20:23], v[168:171], v[208:211], v[20:23]
    ds_read_b128 v[232:235], v11 offset:47104
    ds_read_b128 v[236:239], v11 offset:48128
    v_mfma_f32_16x16x32_bf16 v[20:23], v[160:163], v[196:199], v[20:23]
    v_mfma_f32_16x16x32_bf16 v[24:27], v[160:163], v[200:203], v[24:27]
    v_mfma_f32_16x16x32_bf16 v[24:27], v[168:171], v[212:215], v[24:27]
    v_mfma_f32_16x16x32_bf16 v[28:31], v[172:175], v[204:207], v[28:31]
    v_mfma_f32_16x16x32_bf16 v[28:31], v[164:167], v[192:195], v[28:31]
    v_mfma_f32_16x16x32_bf16 v[32:35], v[164:167], v[196:199], v[32:35]
    v_mfma_f32_16x16x32_bf16 v[32:35], v[172:175], v[208:211], v[32:35]
    v_mfma_f32_16x16x32_bf16 v[36:39], v[172:175], v[212:215], v[36:39]
    v_mfma_f32_16x16x32_bf16 v[36:39], v[164:167], v[200:203], v[36:39]
    s_waitcnt lgkmcnt(0)
    v_mfma_f32_16x16x32_bf16 v[16:19], v[176:179], v[216:219], v[16:19]
    ds_read_b128 v[192:195], v12 offset:0
    ds_read_b128 v[196:199], v12 offset:1024
    v_mfma_f32_16x16x32_bf16 v[16:19], v[184:187], v[228:231], v[16:19]
    ds_read_b128 v[200:203], v12 offset:2048
    ds_read_b128 v[204:207], v12 offset:3072
    v_mfma_f32_16x16x32_bf16 v[20:23], v[184:187], v[232:235], v[20:23]
    ds_read_b128 v[208:211], v12 offset:4096
    ds_read_b128 v[212:215], v12 offset:5120
    v_mfma_f32_16x16x32_bf16 v[20:23], v[176:179], v[220:223], v[20:23]
    v_mfma_f32_16x16x32_bf16 v[24:27], v[176:179], v[224:227], v[24:27]
    v_mfma_f32_16x16x32_bf16 v[24:27], v[184:187], v[236:239], v[24:27]
    v_mfma_f32_16x16x32_bf16 v[28:31], v[188:191], v[228:231], v[28:31]
    v_mfma_f32_16x16x32_bf16 v[28:31], v[180:183], v[216:219], v[28:31]
    v_mfma_f32_16x16x32_bf16 v[32:35], v[180:183], v[220:223], v[32:35]
    v_mfma_f32_16x16x32_bf16 v[32:35], v[188:191], v[232:235], v[32:35]
    v_mfma_f32_16x16x32_bf16 v[36:39], v[188:191], v[236:239], v[36:39]
    v_mfma_f32_16x16x32_bf16 v[36:39], v[180:183], v[224:227], v[36:39]
    s_waitcnt lgkmcnt(0)
    v_mfma_f32_16x16x32_bf16 v[40:43], v[64:67], v[192:195], 0
    ds_read_b128 v[216:219], v12 offset:6144
    ds_read_b128 v[220:223], v12 offset:7168
    v_mfma_f32_16x16x32_bf16 v[40:43], v[72:75], v[204:207], v[40:43]
    ds_read_b128 v[224:227], v12 offset:8192
    ds_read_b128 v[228:231], v12 offset:9216
    v_mfma_f32_16x16x32_bf16 v[44:47], v[72:75], v[208:211], 0
    ds_read_b128 v[232:235], v12 offset:10240
    ds_read_b128 v[236:239], v12 offset:11264
    v_mfma_f32_16x16x32_bf16 v[44:47], v[64:67], v[196:199], v[44:47]
    v_cvt_pk_bf16_f32 v240, v16, v17
    v_cvt_pk_bf16_f32 v241, v18, v19
    v_mfma_f32_16x16x32_bf16 v[48:51], v[64:67], v[200:203], 0
    v_cvt_pk_bf16_f32 v242, v28, v29
    v_cvt_pk_bf16_f32 v243, v30, v31
    v_mfma_f32_16x16x32_bf16 v[48:51], v[72:75], v[212:215], v[48:51]
    buffer_store_dwordx4 v[240:243], v1, s[28:31], s49 offen offset:0 sc1
    v_cvt_pk_bf16_f32 v244, v20, v21
    v_mfma_f32_16x16x32_bf16 v[52:55], v[76:79], v[204:207], 0
    v_cvt_pk_bf16_f32 v245, v22, v23
    v_cvt_pk_bf16_f32 v246, v32, v33
    v_mfma_f32_16x16x32_bf16 v[52:55], v[68:71], v[192:195], v[52:55]
    v_cvt_pk_bf16_f32 v247, v34, v35
    buffer_store_dwordx4 v[244:247], v1, s[28:31], s49 offen offset:1024 sc1
    v_mfma_f32_16x16x32_bf16 v[56:59], v[68:71], v[196:199], 0
    v_cvt_pk_bf16_f32 v248, v24, v25
    v_cvt_pk_bf16_f32 v249, v26, v27
    v_mfma_f32_16x16x32_bf16 v[56:59], v[76:79], v[208:211], v[56:59]
    v_cvt_pk_bf16_f32 v250, v36, v37
    v_cvt_pk_bf16_f32 v251, v38, v39
    v_mfma_f32_16x16x32_bf16 v[60:63], v[76:79], v[212:215], 0
    buffer_store_dwordx4 v[248:251], v1, s[28:31], s49 offen offset:2048 sc1
    v_mfma_f32_16x16x32_bf16 v[60:63], v[68:71], v[200:203], v[60:63]
    s_waitcnt lgkmcnt(0)
    v_mfma_f32_16x16x32_bf16 v[40:43], v[80:83], v[216:219], v[40:43]
    ds_read_b128 v[192:195], v12 offset:12288
    ds_read_b128 v[196:199], v12 offset:13312
    v_mfma_f32_16x16x32_bf16 v[40:43], v[88:91], v[228:231], v[40:43]
    ds_read_b128 v[200:203], v12 offset:14336
    ds_read_b128 v[204:207], v12 offset:15360
    v_mfma_f32_16x16x32_bf16 v[44:47], v[88:91], v[232:235], v[44:47]
    ds_read_b128 v[208:211], v12 offset:16384
    ds_read_b128 v[212:215], v12 offset:17408
    v_mfma_f32_16x16x32_bf16 v[44:47], v[80:83], v[220:223], v[44:47]
    v_mfma_f32_16x16x32_bf16 v[48:51], v[80:83], v[224:227], v[48:51]
    v_mfma_f32_16x16x32_bf16 v[48:51], v[88:91], v[236:239], v[48:51]
    v_mfma_f32_16x16x32_bf16 v[52:55], v[92:95], v[228:231], v[52:55]
    v_mfma_f32_16x16x32_bf16 v[52:55], v[84:87], v[216:219], v[52:55]
    v_mfma_f32_16x16x32_bf16 v[56:59], v[84:87], v[220:223], v[56:59]
    v_mfma_f32_16x16x32_bf16 v[56:59], v[92:95], v[232:235], v[56:59]
    v_mfma_f32_16x16x32_bf16 v[60:63], v[92:95], v[236:239], v[60:63]
    v_mfma_f32_16x16x32_bf16 v[60:63], v[84:87], v[224:227], v[60:63]
    s_waitcnt lgkmcnt(0)
    v_mfma_f32_16x16x32_bf16 v[40:43], v[96:99], v[192:195], v[40:43]
    ds_read_b128 v[216:219], v12 offset:18432
    ds_read_b128 v[220:223], v12 offset:19456
    v_mfma_f32_16x16x32_bf16 v[40:43], v[104:107], v[204:207], v[40:43]
    ds_read_b128 v[224:227], v12 offset:20480
    ds_read_b128 v[228:231], v12 offset:21504
    v_mfma_f32_16x16x32_bf16 v[44:47], v[104:107], v[208:211], v[44:47]
    ds_read_b128 v[232:235], v12 offset:22528
    ds_read_b128 v[236:239], v12 offset:23552
    v_mfma_f32_16x16x32_bf16 v[44:47], v[96:99], v[196:199], v[44:47]
    v_mfma_f32_16x16x32_bf16 v[48:51], v[96:99], v[200:203], v[48:51]
    v_mfma_f32_16x16x32_bf16 v[48:51], v[104:107], v[212:215], v[48:51]
    v_mfma_f32_16x16x32_bf16 v[52:55], v[108:111], v[204:207], v[52:55]
    v_mfma_f32_16x16x32_bf16 v[52:55], v[100:103], v[192:195], v[52:55]
    v_mfma_f32_16x16x32_bf16 v[56:59], v[100:103], v[196:199], v[56:59]
    v_mfma_f32_16x16x32_bf16 v[56:59], v[108:111], v[208:211], v[56:59]
    v_mfma_f32_16x16x32_bf16 v[60:63], v[108:111], v[212:215], v[60:63]
    v_mfma_f32_16x16x32_bf16 v[60:63], v[100:103], v[200:203], v[60:63]
    s_waitcnt lgkmcnt(0)
    v_mfma_f32_16x16x32_bf16 v[40:43], v[112:115], v[216:219], v[40:43]
    v_mfma_f32_16x16x32_bf16 v[40:43], v[120:123], v[228:231], v[40:43]
    v_mfma_f32_16x16x32_bf16 v[44:47], v[120:123], v[232:235], v[44:47]
    s_barrier
    v_mfma_f32_16x16x32_bf16 v[44:47], v[112:115], v[220:223], v[44:47]
    ds_read_b128 v[192:195], v12 offset:24576
    ds_read_b128 v[196:199], v12 offset:25600
    v_mfma_f32_16x16x32_bf16 v[48:51], v[112:115], v[224:227], v[48:51]
    ds_read_b128 v[200:203], v12 offset:26624
    ds_read_b128 v[204:207], v12 offset:27648
    v_mfma_f32_16x16x32_bf16 v[48:51], v[120:123], v[236:239], v[48:51]
    ds_read_b128 v[208:211], v12 offset:28672
    ds_read_b128 v[212:215], v12 offset:29696
    v_mfma_f32_16x16x32_bf16 v[52:55], v[124:127], v[228:231], v[52:55]
    v_mfma_f32_16x16x32_bf16 v[52:55], v[116:119], v[216:219], v[52:55]
    v_mfma_f32_16x16x32_bf16 v[56:59], v[116:119], v[220:223], v[56:59]
    v_mfma_f32_16x16x32_bf16 v[56:59], v[124:127], v[232:235], v[56:59]
    v_mfma_f32_16x16x32_bf16 v[60:63], v[124:127], v[236:239], v[60:63]
    v_mfma_f32_16x16x32_bf16 v[60:63], v[116:119], v[224:227], v[60:63]
    s_waitcnt lgkmcnt(0)
    v_mfma_f32_16x16x32_bf16 v[40:43], v[128:131], v[192:195], v[40:43]
    ds_read_b128 v[216:219], v12 offset:30720
    ds_read_b128 v[220:223], v12 offset:31744
    v_mfma_f32_16x16x32_bf16 v[40:43], v[136:139], v[204:207], v[40:43]
    ds_read_b128 v[224:227], v12 offset:32768
    ds_read_b128 v[228:231], v12 offset:33792
    v_mfma_f32_16x16x32_bf16 v[44:47], v[136:139], v[208:211], v[44:47]
    ds_read_b128 v[232:235], v12 offset:34816
    ds_read_b128 v[236:239], v12 offset:35840
    v_mfma_f32_16x16x32_bf16 v[44:47], v[128:131], v[196:199], v[44:47]
    v_mfma_f32_16x16x32_bf16 v[48:51], v[128:131], v[200:203], v[48:51]
    v_mfma_f32_16x16x32_bf16 v[48:51], v[136:139], v[212:215], v[48:51]
    v_mfma_f32_16x16x32_bf16 v[52:55], v[140:143], v[204:207], v[52:55]
    v_mfma_f32_16x16x32_bf16 v[52:55], v[132:135], v[192:195], v[52:55]
    v_mfma_f32_16x16x32_bf16 v[56:59], v[132:135], v[196:199], v[56:59]
    v_mfma_f32_16x16x32_bf16 v[56:59], v[140:143], v[208:211], v[56:59]
    v_mfma_f32_16x16x32_bf16 v[60:63], v[140:143], v[212:215], v[60:63]
    v_mfma_f32_16x16x32_bf16 v[60:63], v[132:135], v[200:203], v[60:63]
    s_waitcnt lgkmcnt(0)
    v_mfma_f32_16x16x32_bf16 v[40:43], v[144:147], v[216:219], v[40:43]
    ds_read_b128 v[192:195], v12 offset:36864
    ds_read_b128 v[196:199], v12 offset:37888
    v_mfma_f32_16x16x32_bf16 v[40:43], v[152:155], v[228:231], v[40:43]
    ds_read_b128 v[200:203], v12 offset:38912
    ds_read_b128 v[204:207], v12 offset:39936
    v_mfma_f32_16x16x32_bf16 v[44:47], v[152:155], v[232:235], v[44:47]
    ds_read_b128 v[208:211], v12 offset:40960
    ds_read_b128 v[212:215], v12 offset:41984
    v_mfma_f32_16x16x32_bf16 v[44:47], v[144:147], v[220:223], v[44:47]
    v_mfma_f32_16x16x32_bf16 v[48:51], v[144:147], v[224:227], v[48:51]
    v_mfma_f32_16x16x32_bf16 v[48:51], v[152:155], v[236:239], v[48:51]
    v_mfma_f32_16x16x32_bf16 v[52:55], v[156:159], v[228:231], v[52:55]
    v_mfma_f32_16x16x32_bf16 v[52:55], v[148:151], v[216:219], v[52:55]
    v_mfma_f32_16x16x32_bf16 v[56:59], v[148:151], v[220:223], v[56:59]
    v_mfma_f32_16x16x32_bf16 v[56:59], v[156:159], v[232:235], v[56:59]
    v_mfma_f32_16x16x32_bf16 v[60:63], v[156:159], v[236:239], v[60:63]
    v_mfma_f32_16x16x32_bf16 v[60:63], v[148:151], v[224:227], v[60:63]
    s_waitcnt lgkmcnt(0)
    v_mfma_f32_16x16x32_bf16 v[40:43], v[160:163], v[192:195], v[40:43]
    ds_read_b128 v[216:219], v12 offset:43008
    ds_read_b128 v[220:223], v12 offset:44032
    v_mfma_f32_16x16x32_bf16 v[40:43], v[168:171], v[204:207], v[40:43]
    ds_read_b128 v[224:227], v12 offset:45056
    ds_read_b128 v[228:231], v12 offset:46080
    v_mfma_f32_16x16x32_bf16 v[44:47], v[168:171], v[208:211], v[44:47]
    ds_read_b128 v[232:235], v12 offset:47104
    ds_read_b128 v[236:239], v12 offset:48128
    v_mfma_f32_16x16x32_bf16 v[44:47], v[160:163], v[196:199], v[44:47]
    s_barrier
    v_mfma_f32_16x16x32_bf16 v[48:51], v[160:163], v[200:203], v[48:51]
    v_mfma_f32_16x16x32_bf16 v[48:51], v[168:171], v[212:215], v[48:51]
    v_mfma_f32_16x16x32_bf16 v[52:55], v[172:175], v[204:207], v[52:55]
    v_mfma_f32_16x16x32_bf16 v[52:55], v[164:167], v[192:195], v[52:55]
    v_mfma_f32_16x16x32_bf16 v[56:59], v[164:167], v[196:199], v[56:59]
    v_mfma_f32_16x16x32_bf16 v[56:59], v[172:175], v[208:211], v[56:59]
    v_mfma_f32_16x16x32_bf16 v[60:63], v[172:175], v[212:215], v[60:63]
    v_mfma_f32_16x16x32_bf16 v[60:63], v[164:167], v[200:203], v[60:63]
    s_waitcnt lgkmcnt(0)
    v_mfma_f32_16x16x32_bf16 v[40:43], v[176:179], v[216:219], v[40:43]
    s_waitcnt vmcnt(0)
    s_atomic_or s33, s[34:35], 8
    v_mfma_f32_16x16x32_bf16 v[40:43], v[184:187], v[228:231], v[40:43]
    v_mfma_f32_16x16x32_bf16 v[44:47], v[184:187], v[232:235], v[44:47]
    v_mfma_f32_16x16x32_bf16 v[44:47], v[176:179], v[220:223], v[44:47]
    v_mfma_f32_16x16x32_bf16 v[48:51], v[176:179], v[224:227], v[48:51]
    v_mfma_f32_16x16x32_bf16 v[48:51], v[184:187], v[236:239], v[48:51]
    v_mfma_f32_16x16x32_bf16 v[52:55], v[188:191], v[228:231], v[52:55]
    v_mfma_f32_16x16x32_bf16 v[52:55], v[180:183], v[216:219], v[52:55]
    v_mfma_f32_16x16x32_bf16 v[56:59], v[180:183], v[220:223], v[56:59]
    v_mfma_f32_16x16x32_bf16 v[56:59], v[188:191], v[232:235], v[56:59]
    v_mfma_f32_16x16x32_bf16 v[60:63], v[188:191], v[236:239], v[60:63]
    v_mfma_f32_16x16x32_bf16 v[60:63], v[180:183], v[224:227], v[60:63]
    s_cmp_eq_u32 s36, s37
    s_cbranch_scc1 L_own
    v_cvt_pk_bf16_f32 v16, v40, v41
    v_cvt_pk_bf16_f32 v17, v42, v43
    v_min_u32 v16, -2, v16
    v_min_u32 v17, -2, v17
    v_cvt_pk_bf16_f32 v18, v52, v53
    v_cvt_pk_bf16_f32 v19, v54, v55
    v_min_u32 v18, -2, v18
    v_min_u32 v19, -2, v19
    buffer_store_dwordx4 v[16:19], v1, s[28:31], s48 offen offset:0 sc1
    v_cvt_pk_bf16_f32 v20, v44, v45
    v_cvt_pk_bf16_f32 v21, v46, v47
    v_min_u32 v20, -2, v20
    v_min_u32 v21, -2, v21
    v_cvt_pk_bf16_f32 v22, v56, v57
    v_cvt_pk_bf16_f32 v23, v58, v59
    v_min_u32 v22, -2, v22
    v_min_u32 v23, -2, v23
    buffer_store_dwordx4 v[20:23], v1, s[28:31], s48 offen offset:1024 sc1
    v_cvt_pk_bf16_f32 v24, v48, v49
    v_cvt_pk_bf16_f32 v25, v50, v51
    v_min_u32 v24, -2, v24
    v_min_u32 v25, -2, v25
    v_cvt_pk_bf16_f32 v26, v60, v61
    v_cvt_pk_bf16_f32 v27, v62, v63
    v_min_u32 v26, -2, v26
    v_min_u32 v27, -2, v27
    buffer_store_dwordx4 v[24:27], v1, s[28:31], s48 offen offset:2048 sc1
    s_barrier
    s_endpgm
L_own:
    ds_write_b128 v1, v[40:43] offset:0
    ds_write_b128 v1, v[44:47] offset:1024
    ds_write_b128 v1, v[48:51] offset:2048
    ds_write_b128 v1, v[52:55] offset:3072
    ds_write_b128 v1, v[56:59] offset:4096
    s_nop 0
    ds_write_b128 v1, v[60:63] offset:5120
    s_waitcnt lgkmcnt(0)
    s_barrier
L_end:
    s_endpgm
L_roleA:
    s_mov_b32 s14, 8388608
    s_mov_b32 s15, s7
    s_mov_b32 s26, 786432
    s_mov_b32 s27, s7
    s_mov_b32 s30, 268435456
    s_mov_b32 s31, s7
    s_waitcnt lgkmcnt(0)
    v_lshrrev_b32 v252, 4, v0
    v_xor_b32 v252, v252, v0
    v_and_b32 v252, 15, v252
    v_lshlrev_b32 v252, 4, v252
    v_and_b32 v253, 15, v0
    v_lshl_or_b32 v208, v253, 8, v252
    v_xor_b32 v209, 64, v208
    v_xor_b32 v210, 128, v208
    v_xor_b32 v211, 192, v208
    v_bfe_u32 v252, v0, 2, 3
    s_lshl_b32 s56, s36, 1
    v_xor_b32 v252, s56, v252
    v_lshlrev_b32 v252, 5, v252
    v_lshrrev_b32 v253, 2, v0
    v_lshl_or_b32 v252, v253, 8, v252
    v_and_b32 v253, 3, v0
    v_lshl_or_b32 v212, v253, 3, v252
    v_xor_b32 v213, 32, v212
    v_add_u32 v214, 28672, v208
    v_add_u32 v215, 28672, v209
    v_add_u32 v216, 28672, v210
    v_add_u32 v217, 28672, v211
    v_add_u32 v218, 28672, v212
    v_add_u32 v219, 28672, v213
    v_add_u32 v220, 57344, v208
    v_add_u32 v221, 57344, v209
    v_add_u32 v222, 57344, v210
    v_add_u32 v223, 57344, v211
    v_add_u32 v224, 57344, v212
    v_add_u32 v225, 57344, v213
    v_bfe_u32 v252, v0, 4, 1
    v_lshrrev_b32 v253, 5, v0
    v_lshl_or_b32 v252, v252, 1, v253
    v_xor_b32 v252, v252, v0
    v_and_b32 v252, 15, v252
    v_lshlrev_b32 v252, 4, v252
    v_and_b32 v253, 15, v0
    v_lshl_or_b32 v252, v253, 8, v252
    s_lshl_b32 s56, s36, 13
    v_add_u32 v2, s56, v252
    v_mov_b32 v7, v212
    v_mov_b32 v8, v213
    v_add_u32 v9, 0x10000, v212
    v_add_u32 v10, 0x10000, v213
    v_lshrrev_b32 v252, 4, v0
    s_lshl_b32 s56, s36, 2
    v_add_u32 v252, s56, v252
    v_lshlrev_b32 v253, 1, v252
    v_xor_b32 v253, v253, v0
    v_and_b32 v253, 15, v253
    v_lshlrev_b32 v253, 4, v253
    v_lshl_or_b32 v3, v252, 8, v253
    s_mov_b32 s59, 0x76532410
    s_and_b32 s56, s39, 1
    s_cmp_eq_u32 s56, 1
    s_cselect_b32 s59, 0x76532140, s59
    s_lshl_b32 s58, s42, 18
    s_and_b32 s56, s40, 1
    s_lshl_b32 s56, s56, 17
    s_add_u32 s58, s58, s56
    s_lshr_b32 s57, s40, 1
    s_bfe_u32 s56, s59, 0x30018
    s_xor_b32 s56, s56, s57
    s_lshl_b32 s56, s56, 14
    s_add_u32 s50, s56, s58
    s_bfe_u32 s56, s59, 0x3001c
    s_xor_b32 s56, s56, s57
    s_lshl_b32 s56, s56, 14
    s_add_u32 s51, s56, s58
    s_lshl_b32 s3, s36, 10
    v_and_b32 v4, 15, v0
    v_lshlrev_b32 v4, 4, v4
    v_lshlrev_b32 v254, 25, v0
    v_min_u32 v254, 0x1000000, v254
    v_lshlrev_b32 v254, 4, v254
    v_mov_b32 v255, 1
    s_lshl_b32 s68, s43, 7
    s_add_u32 s68, s68, s36
    s_lshr_b32 s56, s41, 1
    s_lshl2_add_u32 s56, s56, s37
    s_and_b32 s57, s41, 1
    s_lshl3_add_u32 s57, s57, s40
    s_lshl2_add_u32 s69, s56, s36
    s_lshl_b32 s69, s69, 7
    s_add_u32 s69, s69, s57
    s_add_u32 s69, s69, 32768
    v_and_b32 v251, 15, v0
    v_lshlrev_b32 v251, 4, v251
    v_add_u32 v251, 49152, v251
    v_lshrrev_b32 v250, 4, v0
    v_min_u32 v250, 2, v250
    v_lshlrev_b32 v250, 8, v250
    s_lshl_b32 s56, s36, 2
    v_add3_u32 v250, s56, v251, v250
    s_mov_b32 s45, 0x3e0293ee
    s_lshl2_add_u32 s52, s43, s36
    s_lshl_b32 s52, s52, 12
    s_add_u32 s52, s52, 65536
    s_xor_b32 s53, s43, 1
    s_lshl2_add_u32 s53, s53, s36
    s_lshl_b32 s53, s53, 12
    s_add_u32 s53, s53, 65536
    s_xor_b32 s54, s43, 129
    s_lshl2_add_u32 s54, s54, s36
    s_lshl_b32 s54, s54, 12
    s_add_u32 s54, s54, 65536
    s_xor_b32 s55, s68, 16384
    s_mov_b32 s48, 0
    s_andn2_b32 s56, s55, 127
    s_add_u32 s4, s28, s56
    s_addc_u32 s5, s29, 0
    s_lshl_b32 s6, s36, 3
    s_lshl_b32 s6, 1, s6
    s_mov_b32 s59, 0x3102
    s_and_b32 s56, s40, 1
    s_cmp_eq_u32 s56, 1
    s_cselect_b32 s59, 0x3120, s59
    s_lshr_b32 s58, s41, 1
    s_and_b32 s56, s41, 1
    s_lshl2_add_u32 s58, s56, s58
    s_lshl_b32 s1, s36, 12
    s_add_u32 s1, s1, 65536
    s_bfe_u32 s56, s59, 0x20000
    s_xor_b32 s56, s56, s58
    s_xor_b32 s57, s42, 4
    s_lshl3_add_u32 s56, s57, s56
    s_lshl_b32 s56, s56, 14
    s_add_u32 s8, s56, s1
    s_bfe_u32 s56, s59, 0x20004
    s_xor_b32 s56, s56, s58
    s_xor_b32 s57, s42, 4
    s_lshl3_add_u32 s56, s57, s56
    s_lshl_b32 s56, s56, 14
    s_add_u32 s9, s56, s1
    s_bfe_u32 s56, s59, 0x20008
    s_xor_b32 s56, s56, s58
    s_xor_b32 s57, s42, 4
    s_lshl3_add_u32 s56, s57, s56
    s_lshl_b32 s56, s56, 14
    s_add_u32 s10, s56, s1
    s_bfe_u32 s56, s59, 0x2000c
    s_xor_b32 s56, s56, s58
    s_xor_b32 s57, s42, 4
    s_lshl3_add_u32 s56, s57, s56
    s_lshl_b32 s56, s56, 14
    s_add_u32 s11, s56, s1
    s_bfe_u32 s56, s59, 0x20000
    s_xor_b32 s56, s56, s58
    s_xor_b32 s57, s42, 0
    s_lshl3_add_u32 s56, s57, s56
    s_lshl_b32 s56, s56, 14
    s_add_u32 s16, s56, s1
    s_bfe_u32 s56, s59, 0x20004
    s_xor_b32 s56, s56, s58
    s_xor_b32 s57, s42, 0
    s_lshl3_add_u32 s56, s57, s56
    s_lshl_b32 s56, s56, 14
    s_add_u32 s17, s56, s1
    s_bfe_u32 s56, s59, 0x20008
    s_xor_b32 s56, s56, s58
    s_xor_b32 s57, s42, 0
    s_lshl3_add_u32 s56, s57, s56
    s_lshl_b32 s56, s56, 14
    s_add_u32 s18, s56, s1
    s_bfe_u32 s56, s59, 0x2000c
    s_xor_b32 s56, s56, s58
    s_xor_b32 s57, s42, 0
    s_lshl3_add_u32 s56, s57, s56
    s_lshl_b32 s56, s56, 14
    s_add_u32 s19, s56, s1
    v_xor_b32 v5, s41, v0
    v_and_b32 v5, 1, v5
    v_xor_b32 v5, 1, v5
    v_lshlrev_b32 v5, 3, v5
    s_and_b32 s56, s41, 1
    s_andn2_b32 s0, s69, 127
    s_lshl2_add_u32 s0, s56, s0
    s_mul_i32 s56, s36, 3072
    s_add_u32 s56, s56, 135168
    v_add_u32 v15, s56, v1
    v_add_u32 v249, 135168, v1
    s_barrier
    s_nop 0
    ds_read_b128 v[64:67], v208 offset:0
    ds_read_b128 v[68:71], v208 offset:4096
    ds_read_b128 v[72:75], v208 offset:8192
    ds_read_b64_tr_b16 v[88:89], v212 offset:12288
    ds_read_b64_tr_b16 v[90:91], v212 offset:16384
    ds_read_b64_tr_b16 v[92:93], v213 offset:12288
    ds_read_b64_tr_b16 v[94:95], v213 offset:16384
    ds_read_b128 v[76:79], v209 offset:0
    ds_read_b128 v[80:83], v209 offset:4096
    ds_read_b128 v[84:87], v209 offset:8192
    ds_read_b64_tr_b16 v[96:97], v212 offset:20480
    ds_read_b64_tr_b16 v[98:99], v212 offset:24576
    ds_read_b64_tr_b16 v[100:101], v213 offset:20480
    ds_read_b64_tr_b16 v[102:103], v213 offset:24576
    s_waitcnt lgkmcnt(7)
    v_mfma_f32_16x16x32_bf16 v[40:43], v[88:91], v[64:67], 0
    v_mfma_f32_16x16x32_bf16 v[44:47], v[88:91], v[68:71], 0
    v_mfma_f32_16x16x32_bf16 v[48:51], v[88:91], v[72:75], 0
    ds_read_b128 v[104:107], v210 offset:0
    v_mfma_f32_16x16x32_bf16 v[60:63], v[92:95], v[72:75], 0
    ds_read_b128 v[108:111], v210 offset:4096
    v_mfma_f32_16x16x32_bf16 v[56:59], v[92:95], v[68:71], 0
    ds_read_b128 v[112:115], v210 offset:8192
    v_mfma_f32_16x16x32_bf16 v[52:55], v[92:95], v[64:67], 0
    ds_read_b128 v[116:119], v211 offset:0
    s_waitcnt lgkmcnt(4)
    ds_read_b128 v[120:123], v211 offset:4096
    v_mfma_f32_16x16x32_bf16 v[52:55], v[100:103], v[76:79], v[52:55]
    ds_read_b128 v[124:127], v211 offset:8192
    v_mfma_f32_16x16x32_bf16 v[56:59], v[100:103], v[80:83], v[56:59]
    v_mfma_f32_16x16x32_bf16 v[60:63], v[100:103], v[84:87], v[60:63]
    v_mfma_f32_16x16x32_bf16 v[48:51], v[96:99], v[84:87], v[48:51]
    v_mfma_f32_16x16x32_bf16 v[44:47], v[96:99], v[80:83], v[44:47]
    v_mfma_f32_16x16x32_bf16 v[40:43], v[96:99], v[76:79], v[40:43]
    s_waitcnt lgkmcnt(0)
    s_barrier
    s_nop 0
    ds_read_b128 v[64:67], v214 offset:0
    ds_read_b128 v[68:71], v214 offset:4096
    ds_read_b128 v[72:75], v214 offset:8192
    ds_read_b64_tr_b16 v[128:129], v218 offset:12288
    ds_read_b64_tr_b16 v[130:131], v218 offset:16384
    ds_read_b64_tr_b16 v[132:133], v219 offset:12288
    ds_read_b64_tr_b16 v[134:135], v219 offset:16384
    ds_read_b128 v[76:79], v215 offset:0
    ds_read_b128 v[80:83], v215 offset:4096
    ds_read_b128 v[84:87], v215 offset:8192
    ds_read_b64_tr_b16 v[136:137], v218 offset:20480
    ds_read_b64_tr_b16 v[138:139], v218 offset:24576
    ds_read_b64_tr_b16 v[140:141], v219 offset:20480
    ds_read_b64_tr_b16 v[142:143], v219 offset:24576
    s_waitcnt lgkmcnt(7)
    v_mfma_f32_16x16x32_bf16 v[40:43], v[128:131], v[64:67], v[40:43]
    v_mfma_f32_16x16x32_bf16 v[44:47], v[128:131], v[68:71], v[44:47]
    v_mfma_f32_16x16x32_bf16 v[48:51], v[128:131], v[72:75], v[48:51]
    ds_read_b128 v[144:147], v216 offset:0
    v_mfma_f32_16x16x32_bf16 v[60:63], v[132:135], v[72:75], v[60:63]
    ds_read_b128 v[148:151], v216 offset:4096
    v_mfma_f32_16x16x32_bf16 v[56:59], v[132:135], v[68:71], v[56:59]
    ds_read_b128 v[152:155], v216 offset:8192
    v_mfma_f32_16x16x32_bf16 v[52:55], v[132:135], v[64:67], v[52:55]
    ds_read_b128 v[156:159], v217 offset:0
    s_waitcnt lgkmcnt(4)
    ds_read_b128 v[160:163], v217 offset:4096
    v_mfma_f32_16x16x32_bf16 v[52:55], v[140:143], v[76:79], v[52:55]
    ds_read_b128 v[164:167], v217 offset:8192
    v_mfma_f32_16x16x32_bf16 v[56:59], v[140:143], v[80:83], v[56:59]
    v_mfma_f32_16x16x32_bf16 v[60:63], v[140:143], v[84:87], v[60:63]
    v_mfma_f32_16x16x32_bf16 v[48:51], v[136:139], v[84:87], v[48:51]
    v_mfma_f32_16x16x32_bf16 v[44:47], v[136:139], v[80:83], v[44:47]
    v_mfma_f32_16x16x32_bf16 v[40:43], v[136:139], v[76:79], v[40:43]
    v_mfma_f32_16x16x32_bf16 v[16:19], v[88:91], v[104:107], 0
    v_mfma_f32_16x16x32_bf16 v[16:19], v[96:99], v[116:119], v[16:19]
    v_mfma_f32_16x16x32_bf16 v[20:23], v[96:99], v[120:123], 0
    v_mfma_f32_16x16x32_bf16 v[20:23], v[88:91], v[108:111], v[20:23]
    v_mfma_f32_16x16x32_bf16 v[24:27], v[88:91], v[112:115], 0
    v_mfma_f32_16x16x32_bf16 v[24:27], v[96:99], v[124:127], v[24:27]
    v_mfma_f32_16x16x32_bf16 v[28:31], v[100:103], v[116:119], 0
    v_mfma_f32_16x16x32_bf16 v[28:31], v[92:95], v[104:107], v[28:31]
    v_mfma_f32_16x16x32_bf16 v[32:35], v[92:95], v[108:111], 0
    v_mfma_f32_16x16x32_bf16 v[32:35], v[100:103], v[120:123], v[32:35]
    v_mfma_f32_16x16x32_bf16 v[36:39], v[100:103], v[124:127], 0
    v_mfma_f32_16x16x32_bf16 v[36:39], v[92:95], v[112:115], v[36:39]
    s_waitcnt lgkmcnt(0)
    s_barrier
    s_nop 0
    ds_read_b128 v[64:67], v220 offset:0
    ds_read_b128 v[68:71], v220 offset:4096
    ds_read_b128 v[72:75], v220 offset:8192
    ds_read_b64_tr_b16 v[168:169], v224 offset:12288
    ds_read_b64_tr_b16 v[170:171], v224 offset:16384
    ds_read_b64_tr_b16 v[172:173], v225 offset:12288
    ds_read_b64_tr_b16 v[174:175], v225 offset:16384
    ds_read_b128 v[76:79], v221 offset:0
    ds_read_b128 v[80:83], v221 offset:4096
    ds_read_b128 v[84:87], v221 offset:8192
    ds_read_b64_tr_b16 v[176:177], v224 offset:20480
    ds_read_b64_tr_b16 v[178:179], v224 offset:24576
    ds_read_b64_tr_b16 v[180:181], v225 offset:20480
    ds_read_b64_tr_b16 v[182:183], v225 offset:24576
    s_waitcnt lgkmcnt(7)
    v_mfma_f32_16x16x32_bf16 v[40:43], v[168:171], v[64:67], v[40:43]
    v_mfma_f32_16x16x32_bf16 v[44:47], v[168:171], v[68:71], v[44:47]
    v_mfma_f32_16x16x32_bf16 v[48:51], v[168:171], v[72:75], v[48:51]
    ds_read_b128 v[184:187], v222 offset:0
    v_mfma_f32_16x16x32_bf16 v[60:63], v[172:175], v[72:75], v[60:63]
    ds_read_b128 v[188:191], v222 offset:4096
    v_mfma_f32_16x16x32_bf16 v[56:59], v[172:175], v[68:71], v[56:59]
    ds_read_b128 v[192:195], v222 offset:8192
    v_mfma_f32_16x16x32_bf16 v[52:55], v[172:175], v[64:67], v[52:55]
    ds_read_b128 v[196:199], v223 offset:0
    s_waitcnt lgkmcnt(4)
    ds_read_b128 v[200:203], v223 offset:4096
    v_mfma_f32_16x16x32_bf16 v[52:55], v[180:183], v[76:79], v[52:55]
    ds_read_b128 v[204:207], v223 offset:8192
    v_mfma_f32_16x16x32_bf16 v[56:59], v[180:183], v[80:83], v[56:59]
    v_mfma_f32_16x16x32_bf16 v[60:63], v[180:183], v[84:87], v[60:63]
    v_mfma_f32_16x16x32_bf16 v[48:51], v[176:179], v[84:87], v[48:51]
    v_mfma_f32_16x16x32_bf16 v[44:47], v[176:179], v[80:83], v[44:47]
    v_mfma_f32_16x16x32_bf16 v[40:43], v[176:179], v[76:79], v[40:43]
    s_waitcnt lgkmcnt(0)
    s_barrier
    s_nop 0
    ds_read_b128 v[64:67], v208 offset:0
    ds_read_b128 v[68:71], v208 offset:4096
    ds_read_b128 v[72:75], v208 offset:8192
    ds_read_b64_tr_b16 v[88:89], v212 offset:12288
    ds_read_b64_tr_b16 v[90:91], v212 offset:16384
    ds_read_b64_tr_b16 v[92:93], v213 offset:12288
    ds_read_b64_tr_b16 v[94:95], v213 offset:16384
    ds_read_b128 v[76:79], v209 offset:0
    ds_read_b128 v[80:83], v209 offset:4096
    ds_read_b128 v[84:87], v209 offset:8192
    ds_read_b64_tr_b16 v[96:97], v212 offset:20480
    ds_read_b64_tr_b16 v[98:99], v212 offset:24576
    ds_read_b64_tr_b16 v[100:101], v213 offset:20480
    ds_read_b64_tr_b16 v[102:103], v213 offset:24576
    s_waitcnt lgkmcnt(7)
    v_mfma_f32_16x16x32_bf16 v[40:43], v[88:91], v[64:67], v[40:43]
    v_mfma_f32_16x16x32_bf16 v[44:47], v[88:91], v[68:71], v[44:47]
    v_mfma_f32_16x16x32_bf16 v[48:51], v[88:91], v[72:75], v[48:51]
    ds_read_b128 v[104:107], v210 offset:0
    v_mfma_f32_16x16x32_bf16 v[60:63], v[92:95], v[72:75], v[60:63]
    ds_read_b128 v[108:111], v210 offset:4096
    v_mfma_f32_16x16x32_bf16 v[56:59], v[92:95], v[68:71], v[56:59]
    ds_read_b128 v[112:115], v210 offset:8192
    v_mfma_f32_16x16x32_bf16 v[52:55], v[92:95], v[64:67], v[52:55]
    ds_read_b128 v[116:119], v211 offset:0
    s_waitcnt lgkmcnt(4)
    ds_read_b128 v[120:123], v211 offset:4096
    v_mfma_f32_16x16x32_bf16 v[52:55], v[100:103], v[76:79], v[52:55]
    ds_read_b128 v[124:127], v211 offset:8192
    v_mfma_f32_16x16x32_bf16 v[56:59], v[100:103], v[80:83], v[56:59]
    v_mfma_f32_16x16x32_bf16 v[60:63], v[100:103], v[84:87], v[60:63]
    v_mfma_f32_16x16x32_bf16 v[48:51], v[96:99], v[84:87], v[48:51]
    v_mfma_f32_16x16x32_bf16 v[44:47], v[96:99], v[80:83], v[44:47]
    v_mfma_f32_16x16x32_bf16 v[40:43], v[96:99], v[76:79], v[40:43]
    v_mfma_f32_16x16x32_bf16 v[16:19], v[128:131], v[144:147], v[16:19]
    v_mfma_f32_16x16x32_bf16 v[16:19], v[136:139], v[156:159], v[16:19]
    v_mfma_f32_16x16x32_bf16 v[20:23], v[136:139], v[160:163], v[20:23]
    v_mfma_f32_16x16x32_bf16 v[20:23], v[128:131], v[148:151], v[20:23]
    v_mfma_f32_16x16x32_bf16 v[24:27], v[128:131], v[152:155], v[24:27]
    v_mfma_f32_16x16x32_bf16 v[24:27], v[136:139], v[164:167], v[24:27]
    v_mfma_f32_16x16x32_bf16 v[28:31], v[140:143], v[156:159], v[28:31]
    v_mfma_f32_16x16x32_bf16 v[28:31], v[132:135], v[144:147], v[28:31]
    v_mfma_f32_16x16x32_bf16 v[32:35], v[132:135], v[148:151], v[32:35]
    v_mfma_f32_16x16x32_bf16 v[32:35], v[140:143], v[160:163], v[32:35]
    v_mfma_f32_16x16x32_bf16 v[36:39], v[140:143], v[164:167], v[36:39]
    v_mfma_f32_16x16x32_bf16 v[36:39], v[132:135], v[152:155], v[36:39]
    s_waitcnt lgkmcnt(0)
    s_barrier
    s_nop 0
    ds_read_b128 v[64:67], v214 offset:0
    ds_read_b128 v[68:71], v214 offset:4096
    ds_read_b128 v[72:75], v214 offset:8192
    ds_read_b64_tr_b16 v[128:129], v218 offset:12288
    ds_read_b64_tr_b16 v[130:131], v218 offset:16384
    ds_read_b64_tr_b16 v[132:133], v219 offset:12288
    ds_read_b64_tr_b16 v[134:135], v219 offset:16384
    ds_read_b128 v[76:79], v215 offset:0
    ds_read_b128 v[80:83], v215 offset:4096
    ds_read_b128 v[84:87], v215 offset:8192
    ds_read_b64_tr_b16 v[136:137], v218 offset:20480
    ds_read_b64_tr_b16 v[138:139], v218 offset:24576
    ds_read_b64_tr_b16 v[140:141], v219 offset:20480
    ds_read_b64_tr_b16 v[142:143], v219 offset:24576
    s_waitcnt lgkmcnt(7)
    v_mfma_f32_16x16x32_bf16 v[40:43], v[128:131], v[64:67], v[40:43]
    v_mfma_f32_16x16x32_bf16 v[44:47], v[128:131], v[68:71], v[44:47]
    v_mfma_f32_16x16x32_bf16 v[48:51], v[128:131], v[72:75], v[48:51]
    ds_read_b128 v[144:147], v216 offset:0
    v_mfma_f32_16x16x32_bf16 v[60:63], v[132:135], v[72:75], v[60:63]
    ds_read_b128 v[148:151], v216 offset:4096
    v_mfma_f32_16x16x32_bf16 v[56:59], v[132:135], v[68:71], v[56:59]
    ds_read_b128 v[152:155], v216 offset:8192
    v_mfma_f32_16x16x32_bf16 v[52:55], v[132:135], v[64:67], v[52:55]
    ds_read_b128 v[156:159], v217 offset:0
    s_waitcnt lgkmcnt(4)
    ds_read_b128 v[160:163], v217 offset:4096
    v_mfma_f32_16x16x32_bf16 v[52:55], v[140:143], v[76:79], v[52:55]
    ds_read_b128 v[164:167], v217 offset:8192
    v_mfma_f32_16x16x32_bf16 v[56:59], v[140:143], v[80:83], v[56:59]
    v_mfma_f32_16x16x32_bf16 v[60:63], v[140:143], v[84:87], v[60:63]
    v_mfma_f32_16x16x32_bf16 v[48:51], v[136:139], v[84:87], v[48:51]
    v_mfma_f32_16x16x32_bf16 v[44:47], v[136:139], v[80:83], v[44:47]
    v_mfma_f32_16x16x32_bf16 v[40:43], v[136:139], v[76:79], v[40:43]
    v_mfma_f32_16x16x32_bf16 v[16:19], v[168:171], v[184:187], v[16:19]
    v_mfma_f32_16x16x32_bf16 v[16:19], v[176:179], v[196:199], v[16:19]
    v_mfma_f32_16x16x32_bf16 v[20:23], v[176:179], v[200:203], v[20:23]
    v_mfma_f32_16x16x32_bf16 v[20:23], v[168:171], v[188:191], v[20:23]
    v_mfma_f32_16x16x32_bf16 v[24:27], v[168:171], v[192:195], v[24:27]
    v_mfma_f32_16x16x32_bf16 v[24:27], v[176:179], v[204:207], v[24:27]
    v_mfma_f32_16x16x32_bf16 v[28:31], v[180:183], v[196:199], v[28:31]
    v_mfma_f32_16x16x32_bf16 v[28:31], v[172:175], v[184:187], v[28:31]
    v_mfma_f32_16x16x32_bf16 v[32:35], v[172:175], v[188:191], v[32:35]
    v_mfma_f32_16x16x32_bf16 v[32:35], v[180:183], v[200:203], v[32:35]
    v_mfma_f32_16x16x32_bf16 v[36:39], v[180:183], v[204:207], v[36:39]
    v_mfma_f32_16x16x32_bf16 v[36:39], v[172:175], v[192:195], v[36:39]
    s_waitcnt lgkmcnt(0)
    s_barrier
    s_nop 0
    ds_read_b128 v[64:67], v220 offset:0
    ds_read_b128 v[68:71], v220 offset:4096
    ds_read_b128 v[72:75], v220 offset:8192
    ds_read_b64_tr_b16 v[168:169], v224 offset:12288
    ds_read_b64_tr_b16 v[170:171], v224 offset:16384
    ds_read_b64_tr_b16 v[172:173], v225 offset:12288
    ds_read_b64_tr_b16 v[174:175], v225 offset:16384
    ds_read_b128 v[76:79], v221 offset:0
    ds_read_b128 v[80:83], v221 offset:4096
    ds_read_b128 v[84:87], v221 offset:8192
    ds_read_b64_tr_b16 v[176:177], v224 offset:20480
    ds_read_b64_tr_b16 v[178:179], v224 offset:24576
    ds_read_b64_tr_b16 v[180:181], v225 offset:20480
    ds_read_b64_tr_b16 v[182:183], v225 offset:24576
    s_waitcnt lgkmcnt(7)
    v_mfma_f32_16x16x32_bf16 v[40:43], v[168:171], v[64:67], v[40:43]
    v_mfma_f32_16x16x32_bf16 v[44:47], v[168:171], v[68:71], v[44:47]
    v_mfma_f32_16x16x32_bf16 v[48:51], v[168:171], v[72:75], v[48:51]
    ds_read_b128 v[184:187], v222 offset:0
    v_mfma_f32_16x16x32_bf16 v[60:63], v[172:175], v[72:75], v[60:63]
    ds_read_b128 v[188:191], v222 offset:4096
    v_mfma_f32_16x16x32_bf16 v[56:59], v[172:175], v[68:71], v[56:59]
    ds_read_b128 v[192:195], v222 offset:8192
    v_mfma_f32_16x16x32_bf16 v[52:55], v[172:175], v[64:67], v[52:55]
    ds_read_b128 v[196:199], v223 offset:0
    s_waitcnt lgkmcnt(4)
    ds_read_b128 v[200:203], v223 offset:4096
    v_mfma_f32_16x16x32_bf16 v[52:55], v[180:183], v[76:79], v[52:55]
    ds_read_b128 v[204:207], v223 offset:8192
    v_mfma_f32_16x16x32_bf16 v[56:59], v[180:183], v[80:83], v[56:59]
    v_mfma_f32_16x16x32_bf16 v[60:63], v[180:183], v[84:87], v[60:63]
    v_mfma_f32_16x16x32_bf16 v[48:51], v[176:179], v[84:87], v[48:51]
    v_mfma_f32_16x16x32_bf16 v[44:47], v[176:179], v[80:83], v[44:47]
    v_mfma_f32_16x16x32_bf16 v[40:43], v[176:179], v[76:79], v[40:43]
    v_mfma_f32_16x16x32_bf16 v[16:19], v[88:91], v[104:107], v[16:19]
    v_mfma_f32_16x16x32_bf16 v[16:19], v[96:99], v[116:119], v[16:19]
    v_mfma_f32_16x16x32_bf16 v[20:23], v[96:99], v[120:123], v[20:23]
    v_mfma_f32_16x16x32_bf16 v[20:23], v[88:91], v[108:111], v[20:23]
    v_mfma_f32_16x16x32_bf16 v[24:27], v[88:91], v[112:115], v[24:27]
    v_mfma_f32_16x16x32_bf16 v[24:27], v[96:99], v[124:127], v[24:27]
    v_mfma_f32_16x16x32_bf16 v[28:31], v[100:103], v[116:119], v[28:31]
    v_mfma_f32_16x16x32_bf16 v[28:31], v[92:95], v[104:107], v[28:31]
    v_mfma_f32_16x16x32_bf16 v[32:35], v[92:95], v[108:111], v[32:35]
    v_mfma_f32_16x16x32_bf16 v[32:35], v[100:103], v[120:123], v[32:35]
    v_mfma_f32_16x16x32_bf16 v[36:39], v[100:103], v[124:127], v[36:39]
    v_mfma_f32_16x16x32_bf16 v[36:39], v[92:95], v[112:115], v[36:39]
    s_waitcnt lgkmcnt(0)
    s_barrier
    s_nop 0
    ds_read_b128 v[64:67], v208 offset:0
    ds_read_b128 v[68:71], v208 offset:4096
    ds_read_b128 v[72:75], v208 offset:8192
    ds_read_b64_tr_b16 v[88:89], v212 offset:12288
    ds_read_b64_tr_b16 v[90:91], v212 offset:16384
    ds_read_b64_tr_b16 v[92:93], v213 offset:12288
    ds_read_b64_tr_b16 v[94:95], v213 offset:16384
    ds_read_b128 v[76:79], v209 offset:0
    ds_read_b128 v[80:83], v209 offset:4096
    ds_read_b128 v[84:87], v209 offset:8192
    ds_read_b64_tr_b16 v[96:97], v212 offset:20480
    ds_read_b64_tr_b16 v[98:99], v212 offset:24576
    ds_read_b64_tr_b16 v[100:101], v213 offset:20480
    ds_read_b64_tr_b16 v[102:103], v213 offset:24576
    s_waitcnt lgkmcnt(7)
    v_mfma_f32_16x16x32_bf16 v[40:43], v[88:91], v[64:67], v[40:43]
    v_mfma_f32_16x16x32_bf16 v[44:47], v[88:91], v[68:71], v[44:47]
    v_mfma_f32_16x16x32_bf16 v[48:51], v[88:91], v[72:75], v[48:51]
    ds_read_b128 v[104:107], v210 offset:0
    v_mfma_f32_16x16x32_bf16 v[60:63], v[92:95], v[72:75], v[60:63]
    ds_read_b128 v[108:111], v210 offset:4096
    v_mfma_f32_16x16x32_bf16 v[56:59], v[92:95], v[68:71], v[56:59]
    ds_read_b128 v[112:115], v210 offset:8192
    v_mfma_f32_16x16x32_bf16 v[52:55], v[92:95], v[64:67], v[52:55]
    ds_read_b128 v[116:119], v211 offset:0
    s_waitcnt lgkmcnt(4)
    ds_read_b128 v[120:123], v211 offset:4096
    v_mfma_f32_16x16x32_bf16 v[52:55], v[100:103], v[76:79], v[52:55]
    ds_read_b128 v[124:127], v211 offset:8192
    v_mfma_f32_16x16x32_bf16 v[56:59], v[100:103], v[80:83], v[56:59]
    v_mfma_f32_16x16x32_bf16 v[60:63], v[100:103], v[84:87], v[60:63]
    v_mfma_f32_16x16x32_bf16 v[48:51], v[96:99], v[84:87], v[48:51]
    v_mfma_f32_16x16x32_bf16 v[44:47], v[96:99], v[80:83], v[44:47]
    v_mfma_f32_16x16x32_bf16 v[40:43], v[96:99], v[76:79], v[40:43]
    v_mfma_f32_16x16x32_bf16 v[16:19], v[128:131], v[144:147], v[16:19]
    v_mfma_f32_16x16x32_bf16 v[16:19], v[136:139], v[156:159], v[16:19]
    v_mfma_f32_16x16x32_bf16 v[20:23], v[136:139], v[160:163], v[20:23]
    v_mfma_f32_16x16x32_bf16 v[20:23], v[128:131], v[148:151], v[20:23]
    v_mfma_f32_16x16x32_bf16 v[24:27], v[128:131], v[152:155], v[24:27]
    v_mfma_f32_16x16x32_bf16 v[24:27], v[136:139], v[164:167], v[24:27]
    v_mfma_f32_16x16x32_bf16 v[28:31], v[140:143], v[156:159], v[28:31]
    v_mfma_f32_16x16x32_bf16 v[28:31], v[132:135], v[144:147], v[28:31]
    v_mfma_f32_16x16x32_bf16 v[32:35], v[132:135], v[148:151], v[32:35]
    v_mfma_f32_16x16x32_bf16 v[32:35], v[140:143], v[160:163], v[32:35]
    v_mfma_f32_16x16x32_bf16 v[36:39], v[140:143], v[164:167], v[36:39]
    v_mfma_f32_16x16x32_bf16 v[36:39], v[132:135], v[152:155], v[36:39]
    s_waitcnt lgkmcnt(0)
    s_barrier
    s_nop 0
    ds_read_b128 v[64:67], v214 offset:0
    ds_read_b128 v[68:71], v214 offset:4096
    ds_read_b128 v[72:75], v214 offset:8192
    ds_read_b64_tr_b16 v[128:129], v218 offset:12288
    ds_read_b64_tr_b16 v[130:131], v218 offset:16384
    ds_read_b64_tr_b16 v[132:133], v219 offset:12288
    ds_read_b64_tr_b16 v[134:135], v219 offset:16384
    ds_read_b128 v[76:79], v215 offset:0
    ds_read_b128 v[80:83], v215 offset:4096
    ds_read_b128 v[84:87], v215 offset:8192
    ds_read_b64_tr_b16 v[136:137], v218 offset:20480
    ds_read_b64_tr_b16 v[138:139], v218 offset:24576
    ds_read_b64_tr_b16 v[140:141], v219 offset:20480
    ds_read_b64_tr_b16 v[142:143], v219 offset:24576
    s_waitcnt lgkmcnt(7)
    v_mfma_f32_16x16x32_bf16 v[40:43], v[128:131], v[64:67], v[40:43]
    v_mfma_f32_16x16x32_bf16 v[44:47], v[128:131], v[68:71], v[44:47]
    v_mfma_f32_16x16x32_bf16 v[48:51], v[128:131], v[72:75], v[48:51]
    ds_read_b128 v[144:147], v216 offset:0
    v_mfma_f32_16x16x32_bf16 v[60:63], v[132:135], v[72:75], v[60:63]
    ds_read_b128 v[148:151], v216 offset:4096
    v_mfma_f32_16x16x32_bf16 v[56:59], v[132:135], v[68:71], v[56:59]
    ds_read_b128 v[152:155], v216 offset:8192
    v_mfma_f32_16x16x32_bf16 v[52:55], v[132:135], v[64:67], v[52:55]
    ds_read_b128 v[156:159], v217 offset:0
    s_waitcnt lgkmcnt(4)
    ds_read_b128 v[160:163], v217 offset:4096
    v_mfma_f32_16x16x32_bf16 v[52:55], v[140:143], v[76:79], v[52:55]
    ds_read_b128 v[164:167], v217 offset:8192
    v_mfma_f32_16x16x32_bf16 v[56:59], v[140:143], v[80:83], v[56:59]
    v_mfma_f32_16x16x32_bf16 v[60:63], v[140:143], v[84:87], v[60:63]
    v_mfma_f32_16x16x32_bf16 v[48:51], v[136:139], v[84:87], v[48:51]
    v_mfma_f32_16x16x32_bf16 v[44:47], v[136:139], v[80:83], v[44:47]
    v_mfma_f32_16x16x32_bf16 v[40:43], v[136:139], v[76:79], v[40:43]
    v_mfma_f32_16x16x32_bf16 v[16:19], v[168:171], v[184:187], v[16:19]
    v_mfma_f32_16x16x32_bf16 v[16:19], v[176:179], v[196:199], v[16:19]
    v_mfma_f32_16x16x32_bf16 v[20:23], v[176:179], v[200:203], v[20:23]
    s_nop 4
    v_cvt_pk_bf16_f32 v228, v40, v41
    v_cvt_pk_bf16_f32 v229, v42, v43
    v_cvt_pk_bf16_f32 v230, v52, v53
    v_mfma_f32_16x16x32_bf16 v[20:23], v[168:171], v[188:191], v[20:23]
    v_cvt_pk_bf16_f32 v231, v54, v55
    v_cvt_pk_bf16_f32 v232, v44, v45
    v_cvt_pk_bf16_f32 v233, v46, v47
    v_mfma_f32_16x16x32_bf16 v[24:27], v[168:171], v[192:195], v[24:27]
    v_cvt_pk_bf16_f32 v234, v56, v57
    v_cvt_pk_bf16_f32 v235, v58, v59
    v_cvt_pk_bf16_f32 v236, v48, v49
    v_mfma_f32_16x16x32_bf16 v[24:27], v[176:179], v[204:207], v[24:27]
    v_cvt_pk_bf16_f32 v237, v50, v51
    v_cvt_pk_bf16_f32 v238, v60, v61
    v_cvt_pk_bf16_f32 v239, v62, v63
    v_mfma_f32_16x16x32_bf16 v[28:31], v[180:183], v[196:199], v[28:31]
    buffer_store_dwordx4 v[228:231], v1, s[28:31], s54 offen offset:0 sc1
    buffer_store_dwordx4 v[232:235], v1, s[28:31], s54 offen offset:1024 sc1
    buffer_store_dwordx4 v[236:239], v1, s[28:31], s54 offen offset:2048 sc1
    v_mfma_f32_16x16x32_bf16 v[28:31], v[172:175], v[184:187], v[28:31]
    s_waitcnt lgkmcnt(0)
    s_barrier
    v_mfma_f32_16x16x32_bf16 v[32:35], v[172:175], v[188:191], v[32:35]
    v_mfma_f32_16x16x32_bf16 v[32:35], v[180:183], v[200:203], v[32:35]
    v_mfma_f32_16x16x32_bf16 v[36:39], v[180:183], v[204:207], v[36:39]
    v_mfma_f32_16x16x32_bf16 v[36:39], v[172:175], v[192:195], v[36:39]
    v_mfma_f32_16x16x32_bf16 v[16:19], v[88:91], v[104:107], v[16:19]
    v_mfma_f32_16x16x32_bf16 v[16:19], v[96:99], v[116:119], v[16:19]
    v_mfma_f32_16x16x32_bf16 v[20:23], v[96:99], v[120:123], v[20:23]
    v_mfma_f32_16x16x32_bf16 v[20:23], v[88:91], v[108:111], v[20:23]
    v_mfma_f32_16x16x32_bf16 v[24:27], v[88:91], v[112:115], v[24:27]
    v_mfma_f32_16x16x32_bf16 v[24:27], v[96:99], v[124:127], v[24:27]
    v_mfma_f32_16x16x32_bf16 v[28:31], v[100:103], v[116:119], v[28:31]
    v_mfma_f32_16x16x32_bf16 v[28:31], v[92:95], v[104:107], v[28:31]
    v_mfma_f32_16x16x32_bf16 v[32:35], v[92:95], v[108:111], v[32:35]
    v_mfma_f32_16x16x32_bf16 v[32:35], v[100:103], v[120:123], v[32:35]
    v_mfma_f32_16x16x32_bf16 v[36:39], v[100:103], v[124:127], v[36:39]
    v_mfma_f32_16x16x32_bf16 v[36:39], v[92:95], v[112:115], v[36:39]
    v_mfma_f32_16x16x32_bf16 v[16:19], v[128:131], v[144:147], v[16:19]
    v_mfma_f32_16x16x32_bf16 v[16:19], v[136:139], v[156:159], v[16:19]
    v_mfma_f32_16x16x32_bf16 v[20:23], v[136:139], v[160:163], v[20:23]
    v_mfma_f32_16x16x32_bf16 v[20:23], v[128:131], v[148:151], v[20:23]
    v_mfma_f32_16x16x32_bf16 v[24:27], v[128:131], v[152:155], v[24:27]
    v_mfma_f32_16x16x32_bf16 v[24:27], v[136:139], v[164:167], v[24:27]
    v_mfma_f32_16x16x32_bf16 v[28:31], v[140:143], v[156:159], v[28:31]
    v_mfma_f32_16x16x32_bf16 v[28:31], v[132:135], v[144:147], v[28:31]
    v_mfma_f32_16x16x32_bf16 v[32:35], v[132:135], v[148:151], v[32:35]
    v_mfma_f32_16x16x32_bf16 v[32:35], v[140:143], v[160:163], v[32:35]
    v_mfma_f32_16x16x32_bf16 v[36:39], v[140:143], v[164:167], v[36:39]
    v_mfma_f32_16x16x32_bf16 v[36:39], v[132:135], v[152:155], v[36:39]
    s_lshr_b32 s56, s41, 1
    s_lshl2_add_u32 s56, s56, s37
    s_and_b32 s57, s41, 1
    s_lshl3_add_u32 s57, s57, s40
    s_lshl_b32 s56, s56, 4
    s_add_u32 s34, s32, s56
    s_addc_u32 s35, s33, 0
    s_load_dwordx4 s[60:63], s[34:35], 0
    s_getreg_b32 s56, hwreg(HW_REG_XCC_ID)
    s_and_b32 s56, s56, 15
    s_or_b32 s56, s56, 0x80
    s_mul_i32 s64, s56, 0x01010101
    s_mov_b32 s65, s64
    s_waitcnt lgkmcnt(0)
    s_cmp_eq_u64 s[60:61], s[64:65]
    s_cselect_b32 s47, 1, 0
    s_cmp_eq_u64 s[62:63], s[64:65]
    s_cselect_b32 s47, s47, 0
    s_lshl_b32 s56, s43, 7
    s_add_u32 s34, s28, s56
    s_addc_u32 s35, s29, 0
    s_waitcnt vmcnt(0)
    s_atomic_or s6, s[34:35], 16
    s_mov_b32 s46, 0
L_sp_12:
    s_add_u32 s46, s46, 1
    s_cmp_gt_u32 s46, 1048576
    s_cbranch_scc1 L_end
    s_load_dword s48, s[4:5], 16 glc
    s_waitcnt lgkmcnt(0)
    s_and_b32 s48, s48, s6
    s_cbranch_scc0 L_sp_12
    buffer_load_dwordx4 v[228:231], v1, s[28:31], s53 offen offset:0 sc1
    buffer_load_dwordx4 v[232:235], v1, s[28:31], s53 offen offset:1024 sc1
    buffer_load_dwordx4 v[236:239], v1, s[28:31], s53 offen offset:2048 sc1
    s_barrier
    v_add_u32 v11, 102400, v2
    v_xor_b32 v12, 64, v11
    v_xor_b32 v13, 128, v11
    v_xor_b32 v14, 192, v11
    ds_read_b128 v[64:67], v11 offset:0
    ds_read_b128 v[80:83], v11 offset:4096
    ds_read_b128 v[68:71], v12 offset:0
    ds_read_b128 v[84:87], v12 offset:4096
    ds_read_b128 v[72:75], v13 offset:0
    ds_read_b128 v[88:91], v13 offset:4096
    ds_read_b128 v[76:79], v14 offset:0
    ds_read_b128 v[92:95], v14 offset:4096
    s_waitcnt lgkmcnt(6)
    v_add_u32 v11, 0, v2
    v_xor_b32 v12, 64, v11
    v_xor_b32 v13, 128, v11
    v_xor_b32 v14, 192, v11
    ds_read_b128 v[96:99], v11 offset:0
    ds_read_b128 v[112:115], v11 offset:4096
    ds_read_b128 v[100:103], v12 offset:0
    ds_read_b128 v[116:119], v12 offset:4096
    ds_read_b128 v[104:107], v13 offset:0
    ds_read_b128 v[120:123], v13 offset:4096
    ds_read_b128 v[108:111], v14 offset:0
    ds_read_b128 v[124:127], v14 offset:4096
    s_waitcnt lgkmcnt(6)
    v_add_u32 v11, 32768, v2
    v_xor_b32 v12, 64, v11
    v_xor_b32 v13, 128, v11
    v_xor_b32 v14, 192, v11
    ds_read_b128 v[128:131], v11 offset:0
    ds_read_b128 v[144:147], v11 offset:4096
    ds_read_b128 v[132:135], v12 offset:0
    ds_read_b128 v[148:151], v12 offset:4096
    ds_read_b128 v[136:139], v13 offset:0
    ds_read_b128 v[152:155], v13 offset:4096
    ds_read_b128 v[140:143], v14 offset:0
    ds_read_b128 v[156:159], v14 offset:4096
    s_waitcnt vmcnt(0)
    v_lshlrev_b32 v244, 16, v228
    v_and_b32 v245, 0xffff0000, v228
    v_pk_add_f32 v[16:17], v[16:17], v[244:245]
    v_lshlrev_b32 v244, 16, v229
    v_and_b32 v245, 0xffff0000, v229
    v_pk_add_f32 v[18:19], v[18:19], v[244:245]
    v_lshlrev_b32 v244, 16, v230
    v_and_b32 v245, 0xffff0000, v230
    v_pk_add_f32 v[28:29], v[28:29], v[244:245]
    v_lshlrev_b32 v244, 16, v231
    v_and_b32 v245, 0xffff0000, v231
    v_pk_add_f32 v[30:31], v[30:31], v[244:245]
    v_cvt_pk_bf16_f32 v216, v16, v17
    v_cvt_pk_bf16_f32 v217, v18, v19
    v_cvt_pk_bf16_f32 v218, v28, v29
    v_cvt_pk_bf16_f32 v219, v30, v31
    s_nop 0
    v_permlane16_swap_b32 v216, v218
    v_permlane16_swap_b32 v217, v219
    ds_write_b128 v15, v[216:219] offset:0
    v_lshlrev_b32 v244, 16, v232
    v_and_b32 v245, 0xffff0000, v232
    v_pk_add_f32 v[20:21], v[20:21], v[244:245]
    v_lshlrev_b32 v244, 16, v233
    v_and_b32 v245, 0xffff0000, v233
    v_pk_add_f32 v[22:23], v[22:23], v[244:245]
    v_lshlrev_b32 v244, 16, v234
    v_and_b32 v245, 0xffff0000, v234
    v_pk_add_f32 v[32:33], v[32:33], v[244:245]
    v_lshlrev_b32 v244, 16, v235
    v_and_b32 v245, 0xffff0000, v235
    v_pk_add_f32 v[34:35], v[34:35], v[244:245]
    v_cvt_pk_bf16_f32 v220, v20, v21
    v_cvt_pk_bf16_f32 v221, v22, v23
    v_cvt_pk_bf16_f32 v222, v32, v33
    v_cvt_pk_bf16_f32 v223, v34, v35
    s_nop 0
    v_permlane16_swap_b32 v220, v222
    v_permlane16_swap_b32 v221, v223
    ds_write_b128 v15, v[220:223] offset:1024
    v_lshlrev_b32 v244, 16, v236
    v_and_b32 v245, 0xffff0000, v236
    v_pk_add_f32 v[24:25], v[24:25], v[244:245]
    v_lshlrev_b32 v244, 16, v237
    v_and_b32 v245, 0xffff0000, v237
    v_pk_add_f32 v[26:27], v[26:27], v[244:245]
    v_lshlrev_b32 v244, 16, v238
    v_and_b32 v245, 0xffff0000, v238
    v_pk_add_f32 v[36:37], v[36:37], v[244:245]
    v_lshlrev_b32 v244, 16, v239
    v_and_b32 v245, 0xffff0000, v239
    v_pk_add_f32 v[38:39], v[38:39], v[244:245]
    v_cvt_pk_bf16_f32 v224, v24, v25
    v_cvt_pk_bf16_f32 v225, v26, v27
    v_cvt_pk_bf16_f32 v226, v36, v37
    v_cvt_pk_bf16_f32 v227, v38, v39
    s_nop 0
    v_permlane16_swap_b32 v224, v226
    v_permlane16_swap_b32 v225, v227
    ds_write_b128 v15, v[224:227] offset:2048
    s_cmp_eq_u32 s47, 0
    s_cbranch_scc1 L_slow_13
    buffer_store_dwordx4 v[216:219], v1, s[28:31], s53 offen offset:0
    buffer_store_dwordx4 v[220:223], v1, s[28:31], s53 offen offset:1024
    buffer_store_dwordx4 v[224:227], v1, s[28:31], s53 offen offset:2048
L_join_14:
    s_waitcnt lgkmcnt(0)
    s_barrier
    ds_read_b128 v[16:19], v249 offset:0
    ds_read_b128 v[20:23], v249 offset:1024
    ds_read_b128 v[24:27], v249 offset:2048
    ds_read_b128 v[28:31], v249 offset:3072
    ds_read_b128 v[32:35], v249 offset:4096
    ds_read_b128 v[36:39], v249 offset:5120
    ds_read_b128 v[40:43], v249 offset:6144
    ds_read_b128 v[44:47], v249 offset:7168
    ds_read_b128 v[48:51], v249 offset:8192
    ds_read_b128 v[52:55], v249 offset:9216
    ds_read_b128 v[56:59], v249 offset:10240
    ds_read_b128 v[60:63], v249 offset:11264
    s_waitcnt lgkmcnt(9)
    v_mfma_f32_16x16x32_bf16 v[192:195], v[64:67], v[16:19], 0
    v_mfma_f32_16x16x32_bf16 v[196:199], v[64:67], v[20:23], 0
    v_mfma_f32_16x16x32_bf16 v[200:203], v[64:67], v[24:27], 0
    v_mfma_f32_16x16x32_bf16 v[204:207], v[80:83], v[16:19], 0
    v_mfma_f32_16x16x32_bf16 v[208:211], v[80:83], v[20:23], 0
    v_mfma_f32_16x16x32_bf16 v[212:215], v[80:83], v[24:27], 0
    s_waitcnt lgkmcnt(6)
    v_mfma_f32_16x16x32_bf16 v[192:195], v[68:71], v[28:31], v[192:195]
    v_mfma_f32_16x16x32_bf16 v[196:199], v[68:71], v[32:35], v[196:199]
    v_mfma_f32_16x16x32_bf16 v[200:203], v[68:71], v[36:39], v[200:203]
    v_mfma_f32_16x16x32_bf16 v[204:207], v[84:87], v[28:31], v[204:207]
    v_mfma_f32_16x16x32_bf16 v[208:211], v[84:87], v[32:35], v[208:211]
    v_mfma_f32_16x16x32_bf16 v[212:215], v[84:87], v[36:39], v[212:215]
    s_waitcnt lgkmcnt(3)
    v_mfma_f32_16x16x32_bf16 v[192:195], v[72:75], v[40:43], v[192:195]
    v_mfma_f32_16x16x32_bf16 v[196:199], v[72:75], v[44:47], v[196:199]
    v_mfma_f32_16x16x32_bf16 v[200:203], v[72:75], v[48:51], v[200:203]
    v_mfma_f32_16x16x32_bf16 v[204:207], v[88:91], v[40:43], v[204:207]
    v_mfma_f32_16x16x32_bf16 v[208:211], v[88:91], v[44:47], v[208:211]
    v_mfma_f32_16x16x32_bf16 v[212:215], v[88:91], v[48:51], v[212:215]
    s_waitcnt lgkmcnt(0)
    v_mfma_f32_16x16x32_bf16 v[192:195], v[76:79], v[52:55], v[192:195]
    v_mfma_f32_16x16x32_bf16 v[196:199], v[76:79], v[56:59], v[196:199]
    v_mfma_f32_16x16x32_bf16 v[200:203], v[76:79], v[60:63], v[200:203]
    v_mfma_f32_16x16x32_bf16 v[204:207], v[92:95], v[52:55], v[204:207]
    v_mfma_f32_16x16x32_bf16 v[208:211], v[92:95], v[56:59], v[208:211]
    v_mfma_f32_16x16x32_bf16 v[212:215], v[92:95], v[60:63], v[212:215]
    s_waitcnt vmcnt(0)
    s_cmp_eq_u32 s47, 0
    s_cbranch_scc1 L_slow_15
    buffer_store_byte v255, v254, s[28:31], s68 offen offset:0
L_join_16:
    v_mfma_f32_16x16x32_bf16 v[64:67], v[96:99], v[16:19], 0
    v_mfma_f32_16x16x32_bf16 v[64:67], v[100:103], v[28:31], v[64:67]
    s_mov_b32 s56, 65536
    s_cmp_eq_u32 s36, 3
    s_cselect_b32 s56, 122880, s56
    v_add_u32 v11, s56, v2
    v_xor_b32 v12, 64, v11
    v_mfma_f32_16x16x32_bf16 v[64:67], v[104:107], v[40:43], v[64:67]
    v_xor_b32 v13, 128, v11
    v_mfma_f32_16x16x32_bf16 v[64:67], v[108:111], v[52:55], v[64:67]
    v_xor_b32 v14, 192, v11
    v_mfma_f32_16x16x32_bf16 v[68:71], v[108:111], v[56:59], 0
    ds_read_b128 v[160:163], v11 offset:0
    v_mfma_f32_16x16x32_bf16 v[68:71], v[104:107], v[44:47], v[68:71]
    ds_read_b128 v[176:179], v11 offset:4096
    v_mfma_f32_16x16x32_bf16 v[68:71], v[100:103], v[32:35], v[68:71]
    ds_read_b128 v[164:167], v12 offset:0
    v_mfma_f32_16x16x32_bf16 v[68:71], v[96:99], v[20:23], v[68:71]
    ds_read_b128 v[180:183], v12 offset:4096
    v_mfma_f32_16x16x32_bf16 v[72:75], v[96:99], v[24:27], 0
    ds_read_b128 v[168:171], v13 offset:0
    v_mfma_f32_16x16x32_bf16 v[72:75], v[100:103], v[36:39], v[72:75]
    ds_read_b128 v[184:187], v13 offset:4096
    v_mfma_f32_16x16x32_bf16 v[72:75], v[104:107], v[48:51], v[72:75]
    ds_read_b128 v[172:175], v14 offset:0
    v_mfma_f32_16x16x32_bf16 v[72:75], v[108:111], v[60:63], v[72:75]
    ds_read_b128 v[188:191], v14 offset:4096
    v_mfma_f32_16x16x32_bf16 v[76:79], v[124:127], v[52:55], 0
    v_max3_f32 v232, v192, v193, v194
    v_mfma_f32_16x16x32_bf16 v[76:79], v[120:123], v[40:43], v[76:79]
    v_max_f32 v232, v232, v195
    v_mfma_f32_16x16x32_bf16 v[76:79], v[116:119], v[28:31], v[76:79]
    v_max3_f32 v233, v196, v197, v198
    v_mfma_f32_16x16x32_bf16 v[76:79], v[112:115], v[16:19], v[76:79]
    v_max_f32 v233, v233, v199
    v_mfma_f32_16x16x32_bf16 v[80:83], v[112:115], v[20:23], 0
    v_max3_f32 v234, v200, v201, v202
    v_mfma_f32_16x16x32_bf16 v[80:83], v[116:119], v[32:35], v[80:83]
    v_max_f32 v234, v234, v203
    v_mfma_f32_16x16x32_bf16 v[80:83], v[120:123], v[44:47], v[80:83]
    v_max3_f32 v232, v232, v204, v205
    v_mfma_f32_16x16x32_bf16 v[80:83], v[124:127], v[56:59], v[80:83]
    v_max3_f32 v232, v232, v206, v207
    v_mfma_f32_16x16x32_bf16 v[84:87], v[124:127], v[60:63], 0
    v_max3_f32 v233, v233, v208, v209
    v_mfma_f32_16x16x32_bf16 v[84:87], v[120:123], v[48:51], v[84:87]
    v_max3_f32 v233, v233, v210, v211
    v_mfma_f32_16x16x32_bf16 v[84:87], v[116:119], v[36:39], v[84:87]
    v_max3_f32 v234, v234, v212, v213
    v_mfma_f32_16x16x32_bf16 v[84:87], v[112:115], v[24:27], v[84:87]
    v_max3_f32 v234, v234, v214, v215
    v_mfma_f32_16x16x32_bf16 v[96:99], v[128:131], v[16:19], 0
    v_mfma_f32_16x16x32_bf16 v[96:99], v[132:135], v[28:31], v[96:99]
    v_max3_f32 v232, v232, v64, v65
    v_mfma_f32_16x16x32_bf16 v[96:99], v[136:139], v[40:43], v[96:99]
    v_max3_f32 v232, v232, v66, v67
    v_mfma_f32_16x16x32_bf16 v[96:99], v[140:143], v[52:55], v[96:99]
    v_mfma_f32_16x16x32_bf16 v[100:103], v[140:143], v[56:59], 0
    v_max3_f32 v233, v233, v68, v69
    v_mfma_f32_16x16x32_bf16 v[100:103], v[136:139], v[44:47], v[100:103]
    v_mfma_f32_16x16x32_bf16 v[100:103], v[132:135], v[32:35], v[100:103]
    v_max3_f32 v233, v233, v70, v71
    v_mfma_f32_16x16x32_bf16 v[100:103], v[128:131], v[20:23], v[100:103]
    v_mfma_f32_16x16x32_bf16 v[104:107], v[128:131], v[24:27], 0
    v_max3_f32 v234, v234, v72, v73
    v_mfma_f32_16x16x32_bf16 v[104:107], v[132:135], v[36:39], v[104:107]
    v_mfma_f32_16x16x32_bf16 v[104:107], v[136:139], v[48:51], v[104:107]
    v_max3_f32 v234, v234, v74, v75
    v_mfma_f32_16x16x32_bf16 v[104:107], v[140:143], v[60:63], v[104:107]
    v_mfma_f32_16x16x32_bf16 v[108:111], v[156:159], v[52:55], 0
    v_max3_f32 v232, v232, v76, v77
    v_mfma_f32_16x16x32_bf16 v[108:111], v[152:155], v[40:43], v[108:111]
    v_mfma_f32_16x16x32_bf16 v[108:111], v[148:151], v[28:31], v[108:111]
    v_max3_f32 v232, v232, v78, v79
    v_mfma_f32_16x16x32_bf16 v[108:111], v[144:147], v[16:19], v[108:111]
    v_mfma_f32_16x16x32_bf16 v[112:115], v[144:147], v[20:23], 0
    v_max3_f32 v233, v233, v80, v81
    v_mfma_f32_16x16x32_bf16 v[112:115], v[148:151], v[32:35], v[112:115]
    v_mfma_f32_16x16x32_bf16 v[112:115], v[152:155], v[44:47], v[112:115]
    v_max3_f32 v233, v233, v82, v83
    v_mfma_f32_16x16x32_bf16 v[112:115], v[156:159], v[56:59], v[112:115]
    v_mfma_f32_16x16x32_bf16 v[116:119], v[156:159], v[60:63], 0
    v_max3_f32 v234, v234, v84, v85
    v_mfma_f32_16x16x32_bf16 v[116:119], v[152:155], v[48:51], v[116:119]
    v_mfma_f32_16x16x32_bf16 v[116:119], v[148:151], v[36:39], v[116:119]
    v_max3_f32 v234, v234, v86, v87
    v_mfma_f32_16x16x32_bf16 v[116:119], v[144:147], v[24:27], v[116:119]
    s_waitcnt lgkmcnt(0)
    v_mfma_f32_16x16x32_bf16 v[128:131], v[160:163], v[16:19], 0
    v_mfma_f32_16x16x32_bf16 v[128:131], v[164:167], v[28:31], v[128:131]
    v_mfma_f32_16x16x32_bf16 v[128:131], v[168:171], v[40:43], v[128:131]
    v_max3_f32 v232, v232, v96, v97
    v_mfma_f32_16x16x32_bf16 v[128:131], v[172:175], v[52:55], v[128:131]
    v_max3_f32 v232, v232, v98, v99
    v_mfma_f32_16x16x32_bf16 v[132:135], v[172:175], v[56:59], 0
    v_max3_f32 v233, v233, v100, v101
    v_mfma_f32_16x16x32_bf16 v[132:135], v[168:171], v[44:47], v[132:135]
    v_max3_f32 v233, v233, v102, v103
    v_mfma_f32_16x16x32_bf16 v[132:135], v[164:167], v[32:35], v[132:135]
    v_max3_f32 v234, v234, v104, v105
    v_mfma_f32_16x16x32_bf16 v[132:135], v[160:163], v[20:23], v[132:135]
    v_max3_f32 v234, v234, v106, v107
    v_mfma_f32_16x16x32_bf16 v[136:139], v[160:163], v[24:27], 0
    v_max3_f32 v232, v232, v108, v109
    v_mfma_f32_16x16x32_bf16 v[136:139], v[164:167], v[36:39], v[136:139]
    v_max3_f32 v232, v232, v110, v111
    v_mfma_f32_16x16x32_bf16 v[136:139], v[168:171], v[48:51], v[136:139]
    v_max3_f32 v233, v233, v112, v113
    v_mfma_f32_16x16x32_bf16 v[136:139], v[172:175], v[60:63], v[136:139]
    v_max3_f32 v233, v233, v114, v115
    v_mfma_f32_16x16x32_bf16 v[140:143], v[188:191], v[52:55], 0
    v_max3_f32 v234, v234, v116, v117
    v_mfma_f32_16x16x32_bf16 v[140:143], v[184:187], v[40:43], v[140:143]
    v_max3_f32 v234, v234, v118, v119
    v_mfma_f32_16x16x32_bf16 v[140:143], v[180:183], v[28:31], v[140:143]
    v_mfma_f32_16x16x32_bf16 v[140:143], v[176:179], v[16:19], v[140:143]
    v_max3_f32 v232, v232, v128, v129
    v_mfma_f32_16x16x32_bf16 v[144:147], v[176:179], v[20:23], 0
    v_max3_f32 v232, v232, v130, v131
    v_mfma_f32_16x16x32_bf16 v[144:147], v[180:183], v[32:35], v[144:147]
    v_max3_f32 v233, v233, v132, v133
    v_mfma_f32_16x16x32_bf16 v[144:147], v[184:187], v[44:47], v[144:147]
    v_max3_f32 v233, v233, v134, v135
    v_mfma_f32_16x16x32_bf16 v[144:147], v[188:191], v[56:59], v[144:147]
    v_max3_f32 v234, v234, v136, v137
    v_mfma_f32_16x16x32_bf16 v[148:151], v[188:191], v[60:63], 0
    v_max3_f32 v234, v234, v138, v139
    v_mfma_f32_16x16x32_bf16 v[148:151], v[184:187], v[48:51], v[148:151]
    s_mul_i32 s56, s36, 3072
    v_mfma_f32_16x16x32_bf16 v[148:151], v[180:183], v[36:39], v[148:151]
    s_add_u32 s56, s56, 114688
    v_mfma_f32_16x16x32_bf16 v[148:151], v[176:179], v[24:27], v[148:151]
    v_add_u32 v15, s56, v1
    v_max3_f32 v232, v232, v140, v141
    v_max3_f32 v232, v232, v142, v143
    v_max3_f32 v233, v233, v144, v145
    v_max3_f32 v233, v233, v146, v147
    s_nop 2
    v_max3_f32 v234, v234, v148, v149
    v_max3_f32 v234, v234, v150, v151
    v_mov_b32 v238, v232
    v_mov_b32 v239, v233
    v_mov_b32 v240, v234
    v_permlane32_swap_b32 v232, v238
    v_permlane32_swap_b32 v233, v239
    v_permlane32_swap_b32 v234, v240
    v_max_f32 v232, v232, v238
    v_max_f32 v233, v233, v239
    v_max_f32 v234, v234, v240
    v_mov_b32 v238, v232
    v_mov_b32 v239, v233
    v_mov_b32 v240, v234
    v_permlane16_swap_b32 v232, v238
    v_permlane16_swap_b32 v233, v239
    v_permlane16_swap_b32 v234, v240
    v_max_f32 v232, v232, v238
    v_max_f32 v233, v233, v239
    v_max_f32 v234, v234, v240
    s_mov_b64 exec, 0xffff
    v_mov_b32 v234, v232
    s_mov_b32 exec_lo, 0xffff0000
    v_mov_b32 v234, v233
    s_mov_b64 exec, -1
    ds_write_b32 v250, v234 offset:0
    s_waitcnt lgkmcnt(0)
    s_barrier
    ds_read_b128 v[238:241], v251 offset:0
    ds_read_b128 v[242:245], v251 offset:256
    ds_read_b128 v[246:249], v251 offset:512
    v_mov_b32 v228, 0x3f803f80
    v_mov_b32 v229, 0x3f803f80
    v_mov_b32 v230, 0x3f803f80
    v_mov_b32 v231, 0x3f803f80
    s_waitcnt lgkmcnt(2)
    v_max3_f32 v238, v238, v239, v240
    v_max_f32 v238, v238, v241
    v_mul_f32 v235, s45, v238
    s_waitcnt lgkmcnt(1)
    v_max3_f32 v242, v242, v243, v244
    v_max_f32 v242, v242, v245
    v_mul_f32 v236, s45, v242
    s_waitcnt lgkmcnt(0)
    v_max3_f32 v246, v246, v247, v248
    v_max_f32 v246, v246, v249
    v_mul_f32 v237, s45, v246
    v_fma_f32 v96, v96, s45, -v235
    v_fma_f32 v97, v97, s45, -v235
    v_fma_f32 v98, v98, s45, -v235
    v_fma_f32 v99, v99, s45, -v235
    v_fma_f32 v108, v108, s45, -v235
    v_fma_f32 v109, v109, s45, -v235
    v_fma_f32 v110, v110, s45, -v235
    v_fma_f32 v111, v111, s45, -v235
    v_exp_f32 v96, v96
    v_exp_f32 v97, v97
    v_fma_f32 v100, v100, s45, -v236
    v_fma_f32 v101, v101, s45, -v236
    v_exp_f32 v98, v98
    v_exp_f32 v99, v99
    v_fma_f32 v102, v102, s45, -v236
    v_fma_f32 v103, v103, s45, -v236
    v_exp_f32 v108, v108
    v_exp_f32 v109, v109
    v_fma_f32 v112, v112, s45, -v236
    v_fma_f32 v113, v113, s45, -v236
    v_exp_f32 v110, v110
    v_exp_f32 v111, v111
    v_fma_f32 v114, v114, s45, -v236
    v_fma_f32 v115, v115, s45, -v236
    v_exp_f32 v100, v100
    v_exp_f32 v101, v101
    v_cvt_pk_bf16_f32 v96, v96, v97
    v_cvt_pk_bf16_f32 v97, v98, v99
    v_cvt_pk_bf16_f32 v98, v108, v109
    v_exp_f32 v102, v102
    v_exp_f32 v103, v103
    v_cvt_pk_bf16_f32 v99, v110, v111
    v_fma_f32 v104, v104, s45, -v237
    v_fma_f32 v105, v105, s45, -v237
    v_exp_f32 v112, v112
    v_exp_f32 v113, v113
    v_fma_f32 v106, v106, s45, -v237
    v_fma_f32 v107, v107, s45, -v237
    v_fma_f32 v116, v116, s45, -v237
    v_exp_f32 v114, v114
    v_exp_f32 v115, v115
    v_fma_f32 v117, v117, s45, -v237
    v_fma_f32 v118, v118, s45, -v237
    v_fma_f32 v119, v119, s45, -v237
    v_exp_f32 v104, v104
    v_exp_f32 v105, v105
    v_mfma_f32_16x16x32_bf16 v[216:219], v[228:231], v[96:99], 0
    v_cvt_pk_bf16_f32 v100, v100, v101
    v_cvt_pk_bf16_f32 v101, v102, v103
    v_cvt_pk_bf16_f32 v102, v112, v113
    v_exp_f32 v106, v106
    v_exp_f32 v107, v107
    v_cvt_pk_bf16_f32 v103, v114, v115
    v_fma_f32 v64, v64, s45, -v235
    v_fma_f32 v65, v65, s45, -v235
    v_exp_f32 v116, v116
    v_exp_f32 v117, v117
    v_fma_f32 v66, v66, s45, -v235
    v_fma_f32 v67, v67, s45, -v235
    v_fma_f32 v76, v76, s45, -v235
    v_exp_f32 v118, v118
    v_exp_f32 v119, v119
    v_fma_f32 v77, v77, s45, -v235
    v_fma_f32 v78, v78, s45, -v235
    v_fma_f32 v79, v79, s45, -v235
    v_exp_f32 v64, v64
    v_exp_f32 v65, v65
    v_mfma_f32_16x16x32_bf16 v[220:223], v[228:231], v[100:103], 0
    v_cvt_pk_bf16_f32 v104, v104, v105
    v_cvt_pk_bf16_f32 v105, v106, v107
    v_cvt_pk_bf16_f32 v106, v116, v117
    v_exp_f32 v66, v66
    v_exp_f32 v67, v67
    v_cvt_pk_bf16_f32 v107, v118, v119
    v_fma_f32 v68, v68, s45, -v236
    v_fma_f32 v69, v69, s45, -v236
    v_exp_f32 v76, v76
    v_exp_f32 v77, v77
    v_fma_f32 v70, v70, s45, -v236
    v_fma_f32 v71, v71, s45, -v236
    v_fma_f32 v80, v80, s45, -v236
    v_exp_f32 v78, v78
    v_exp_f32 v79, v79
    v_fma_f32 v81, v81, s45, -v236
    v_fma_f32 v82, v82, s45, -v236
    v_fma_f32 v83, v83, s45, -v236
    v_exp_f32 v68, v68
    v_exp_f32 v69, v69
    v_mfma_f32_16x16x32_bf16 v[224:227], v[228:231], v[104:107], 0
    v_cvt_pk_bf16_f32 v64, v64, v65
    v_cvt_pk_bf16_f32 v65, v66, v67
    v_cvt_pk_bf16_f32 v66, v76, v77
    v_exp_f32 v70, v70
    v_exp_f32 v71, v71
    v_cvt_pk_bf16_f32 v67, v78, v79
    v_fma_f32 v72, v72, s45, -v237
    v_fma_f32 v73, v73, s45, -v237
    v_exp_f32 v80, v80
    v_exp_f32 v81, v81
    v_fma_f32 v74, v74, s45, -v237
    v_fma_f32 v75, v75, s45, -v237
    v_fma_f32 v84, v84, s45, -v237
    v_exp_f32 v82, v82
    v_exp_f32 v83, v83
    v_fma_f32 v85, v85, s45, -v237
    v_fma_f32 v86, v86, s45, -v237
    v_fma_f32 v87, v87, s45, -v237
    v_exp_f32 v72, v72
    v_exp_f32 v73, v73
    ds_write_b128 v15, v[96:99] offset:24576
    v_mfma_f32_16x16x32_bf16 v[216:219], v[228:231], v[64:67], v[216:219]
    v_cvt_pk_bf16_f32 v68, v68, v69
    v_cvt_pk_bf16_f32 v69, v70, v71
    v_exp_f32 v74, v74
    v_exp_f32 v75, v75
    v_cvt_pk_bf16_f32 v70, v80, v81
    v_cvt_pk_bf16_f32 v71, v82, v83
    v_fma_f32 v128, v128, s45, -v235
    v_fma_f32 v129, v129, s45, -v235
    v_exp_f32 v84, v84
    v_exp_f32 v85, v85
    v_fma_f32 v130, v130, s45, -v235
    ds_write_b128 v15, v[100:103] offset:25600
    v_fma_f32 v131, v131, s45, -v235
    v_fma_f32 v140, v140, s45, -v235
    v_exp_f32 v86, v86
    v_exp_f32 v87, v87
    v_fma_f32 v141, v141, s45, -v235
    v_fma_f32 v142, v142, s45, -v235
    v_fma_f32 v143, v143, s45, -v235
    v_exp_f32 v128, v128
    v_exp_f32 v129, v129
    ds_write_b128 v15, v[104:107] offset:26624
    v_mfma_f32_16x16x32_bf16 v[220:223], v[228:231], v[68:71], v[220:223]
    v_cvt_pk_bf16_f32 v72, v72, v73
    v_cvt_pk_bf16_f32 v73, v74, v75
    v_exp_f32 v130, v130
    v_exp_f32 v131, v131
    v_cvt_pk_bf16_f32 v74, v84, v85
    v_cvt_pk_bf16_f32 v75, v86, v87
    v_fma_f32 v132, v132, s45, -v236
    v_fma_f32 v133, v133, s45, -v236
    v_exp_f32 v140, v140
    v_exp_f32 v141, v141
    v_fma_f32 v134, v134, s45, -v236
    ds_write_b128 v15, v[64:67] offset:12288
    v_fma_f32 v135, v135, s45, -v236
    v_fma_f32 v144, v144, s45, -v236
    v_exp_f32 v142, v142
    v_exp_f32 v143, v143
    v_fma_f32 v145, v145, s45, -v236
    v_fma_f32 v146, v146, s45, -v236
    v_fma_f32 v147, v147, s45, -v236
    v_exp_f32 v132, v132
    v_exp_f32 v133, v133
    ds_write_b128 v15, v[68:71] offset:13312
    v_mfma_f32_16x16x32_bf16 v[224:227], v[228:231], v[72:75], v[224:227]
    v_cvt_pk_bf16_f32 v128, v128, v129
    v_cvt_pk_bf16_f32 v129, v130, v131
    v_exp_f32 v134, v134
    v_exp_f32 v135, v135
    v_cvt_pk_bf16_f32 v130, v140, v141
    v_cvt_pk_bf16_f32 v131, v142, v143
    v_fma_f32 v136, v136, s45, -v237
    v_fma_f32 v137, v137, s45, -v237
    v_exp_f32 v144, v144
    v_exp_f32 v145, v145
    v_fma_f32 v138, v138, s45, -v237
    ds_write_b128 v15, v[72:75] offset:14336
    v_fma_f32 v139, v139, s45, -v237
    v_fma_f32 v148, v148, s45, -v237
    v_exp_f32 v146, v146
    v_exp_f32 v147, v147
    v_fma_f32 v149, v149, s45, -v237
    v_fma_f32 v150, v150, s45, -v237
    v_fma_f32 v151, v151, s45, -v237
    v_exp_f32 v136, v136
    v_exp_f32 v137, v137
    ds_write_b128 v15, v[128:131] offset:36864
    v_mfma_f32_16x16x32_bf16 v[216:219], v[228:231], v[128:131], v[216:219]
    v_cvt_pk_bf16_f32 v132, v132, v133
    v_cvt_pk_bf16_f32 v133, v134, v135
    v_exp_f32 v138, v138
    v_exp_f32 v139, v139
    v_cvt_pk_bf16_f32 v134, v144, v145
    v_cvt_pk_bf16_f32 v135, v146, v147
    v_fma_f32 v192, v192, s45, -v235
    v_exp_f32 v148, v148
    v_exp_f32 v149, v149
    v_fma_f32 v193, v193, s45, -v235
    v_fma_f32 v194, v194, s45, -v235
    v_fma_f32 v195, v195, s45, -v235
    v_fma_f32 v204, v204, s45, -v235
    v_exp_f32 v150, v150
    v_exp_f32 v151, v151
    v_fma_f32 v205, v205, s45, -v235
    v_fma_f32 v206, v206, s45, -v235
    v_fma_f32 v207, v207, s45, -v235
    v_exp_f32 v192, v192
    v_exp_f32 v193, v193
    ds_write_b128 v15, v[132:135] offset:37888
    v_mfma_f32_16x16x32_bf16 v[220:223], v[228:231], v[132:135], v[220:223]
    v_cvt_pk_bf16_f32 v136, v136, v137
    v_cvt_pk_bf16_f32 v137, v138, v139
    v_exp_f32 v194, v194
    v_exp_f32 v195, v195
    v_cvt_pk_bf16_f32 v138, v148, v149
    v_cvt_pk_bf16_f32 v139, v150, v151
    v_fma_f32 v196, v196, s45, -v236
    v_exp_f32 v204, v204
    v_exp_f32 v205, v205
    v_fma_f32 v197, v197, s45, -v236
    v_fma_f32 v198, v198, s45, -v236
    v_fma_f32 v199, v199, s45, -v236
    v_fma_f32 v208, v208, s45, -v236
    v_exp_f32 v206, v206
    v_exp_f32 v207, v207
    v_fma_f32 v209, v209, s45, -v236
    v_fma_f32 v210, v210, s45, -v236
    v_fma_f32 v211, v211, s45, -v236
    v_exp_f32 v196, v196
    v_exp_f32 v197, v197
    ds_write_b128 v15, v[136:139] offset:38912
    v_mfma_f32_16x16x32_bf16 v[224:227], v[228:231], v[136:139], v[224:227]
    v_cvt_pk_bf16_f32 v192, v192, v193
    v_cvt_pk_bf16_f32 v193, v194, v195
    v_exp_f32 v198, v198
    v_exp_f32 v199, v199
    v_cvt_pk_bf16_f32 v194, v204, v205
    v_cvt_pk_bf16_f32 v195, v206, v207
    v_fma_f32 v200, v200, s45, -v237
    v_exp_f32 v208, v208
    v_exp_f32 v209, v209
    v_fma_f32 v201, v201, s45, -v237
    v_fma_f32 v202, v202, s45, -v237
    v_fma_f32 v203, v203, s45, -v237
    v_fma_f32 v212, v212, s45, -v237
    v_exp_f32 v210, v210
    v_exp_f32 v211, v211
    v_fma_f32 v213, v213, s45, -v237
    v_fma_f32 v214, v214, s45, -v237
    v_fma_f32 v215, v215, s45, -v237
    v_exp_f32 v200, v200
    v_exp_f32 v201, v201
    ds_write_b128 v15, v[192:195] offset:0
    v_mfma_f32_16x16x32_bf16 v[216:219], v[228:231], v[192:195], v[216:219]
    v_exp_f32 v202, v202
    v_exp_f32 v203, v203
    v_cvt_pk_bf16_f32 v196, v196, v197
    v_exp_f32 v212, v212
    v_exp_f32 v213, v213
    v_cvt_pk_bf16_f32 v197, v198, v199
    v_cvt_pk_bf16_f32 v198, v208, v209
    v_exp_f32 v214, v214
    v_exp_f32 v215, v215
    v_cvt_pk_bf16_f32 v199, v210, v211
    ds_write_b128 v15, v[196:199] offset:1024
    s_nop 0
    v_mfma_f32_16x16x32_bf16 v[220:223], v[228:231], v[196:199], v[220:223]
    v_cvt_pk_bf16_f32 v200, v200, v201
    v_cvt_pk_bf16_f32 v201, v202, v203
    v_cvt_pk_bf16_f32 v202, v212, v213
    v_cvt_pk_bf16_f32 v203, v214, v215
    ds_write_b128 v15, v[200:203] offset:2048
    s_nop 0
    v_mfma_f32_16x16x32_bf16 v[224:227], v[228:231], v[200:203], v[224:227]
    v_mov_b32 v252, 0
    ds_write_b32 v250, v252 offset:3072
    s_mov_b64 exec, 0xffff
    s_nop 4
    v_mov_b32 v224, v216
    s_mov_b32 exec_lo, 0xffff0000
    v_mov_b32 v224, v220
    s_mov_b64 exec, -1
    ds_write_b32 v250, v224 offset:1536
    v_add_u32 v15, 114688, v1
    s_waitcnt lgkmcnt(0)
    s_barrier
    ds_read_b128 v[40:43], v15 offset:0
    ds_read_b128 v[44:47], v15 offset:1024
    ds_read_b128 v[48:51], v15 offset:2048
    ds_read_b64_tr_b16 v[64:65], v7 offset:0
    ds_read_b64_tr_b16 v[66:67], v7 offset:4096
    ds_read_b64_tr_b16 v[68:69], v8 offset:0
    ds_read_b64_tr_b16 v[70:71], v8 offset:4096
    ds_read_b128 v[52:55], v15 offset:3072
    ds_read_b128 v[56:59], v15 offset:4096
    ds_read_b128 v[60:63], v15 offset:5120
    ds_read_b64_tr_b16 v[72:73], v7 offset:8192
    ds_read_b64_tr_b16 v[74:75], v7 offset:12288
    ds_read_b64_tr_b16 v[76:77], v8 offset:8192
    ds_read_b64_tr_b16 v[78:79], v8 offset:12288
    s_waitcnt lgkmcnt(7)
    v_mfma_f32_16x16x32_bf16 v[16:19], v[64:67], v[40:43], 0
    ds_read_b128 v[192:195], v15 offset:6144
    ds_read_b128 v[196:199], v15 offset:7168
    v_mfma_f32_16x16x32_bf16 v[20:23], v[64:67], v[44:47], 0
    ds_read_b128 v[200:203], v15 offset:8192
    ds_read_b128 v[204:207], v15 offset:9216
    v_mfma_f32_16x16x32_bf16 v[24:27], v[64:67], v[48:51], 0
    ds_read_b128 v[208:211], v15 offset:10240
    ds_read_b128 v[212:215], v15 offset:11264
    v_mfma_f32_16x16x32_bf16 v[28:31], v[68:71], v[40:43], 0
    ds_read_b64_tr_b16 v[80:81], v7 offset:16384
    s_waitcnt lgkmcnt(10)
    ds_read_b64_tr_b16 v[82:83], v7 offset:20480
    v_mfma_f32_16x16x32_bf16 v[32:35], v[68:71], v[44:47], 0
    ds_read_b64_tr_b16 v[84:85], v8 offset:16384
    ds_read_b64_tr_b16 v[86:87], v8 offset:20480
    v_mfma_f32_16x16x32_bf16 v[36:39], v[68:71], v[48:51], 0
    ds_read_b64_tr_b16 v[88:89], v7 offset:24576
    s_waitcnt lgkmcnt(10)
    ds_read_b64_tr_b16 v[90:91], v7 offset:28672
    ds_read_b64_tr_b16 v[92:93], v8 offset:24576
    ds_read_b64_tr_b16 v[94:95], v8 offset:28672
    v_mfma_f32_16x16x32_bf16 v[16:19], v[72:75], v[52:55], v[16:19]
    ds_read_b64_tr_b16 v[96:97], v7 offset:53248
    s_waitcnt lgkmcnt(10)
    ds_read_b64_tr_b16 v[98:99], v7 offset:57344
    v_mfma_f32_16x16x32_bf16 v[20:23], v[72:75], v[56:59], v[20:23]
    ds_read_b64_tr_b16 v[100:101], v8 offset:53248
    ds_read_b64_tr_b16 v[102:103], v8 offset:57344
    v_mfma_f32_16x16x32_bf16 v[24:27], v[72:75], v[60:63], v[24:27]
    ds_read_b64_tr_b16 v[104:105], v9 offset:36864
    s_waitcnt lgkmcnt(10)
    ds_read_b64_tr_b16 v[106:107], v9 offset:40960
    v_mfma_f32_16x16x32_bf16 v[28:31], v[76:79], v[52:55], v[28:31]
    ds_read_b64_tr_b16 v[108:109], v10 offset:36864
    ds_read_b64_tr_b16 v[110:111], v10 offset:40960
    v_mfma_f32_16x16x32_bf16 v[32:35], v[76:79], v[56:59], v[32:35]
    v_mfma_f32_16x16x32_bf16 v[36:39], v[76:79], v[60:63], v[36:39]
    s_waitcnt lgkmcnt(12)
    s_waitcnt lgkmcnt(8)
    v_mfma_f32_16x16x32_bf16 v[16:19], v[80:83], v[192:195], v[16:19]
    ds_read_b128 v[40:43], v15 offset:12288
    ds_read_b128 v[44:47], v15 offset:13312
    v_mfma_f32_16x16x32_bf16 v[16:19], v[88:91], v[204:207], v[16:19]
    ds_read_b128 v[48:51], v15 offset:14336
    ds_read_b128 v[52:55], v15 offset:15360
    v_mfma_f32_16x16x32_bf16 v[20:23], v[88:91], v[208:211], v[20:23]
    ds_read_b128 v[56:59], v15 offset:16384
    ds_read_b128 v[60:63], v15 offset:17408
    v_mfma_f32_16x16x32_bf16 v[20:23], v[80:83], v[196:199], v[20:23]
    s_waitcnt lgkmcnt(10)
    ds_read_b64_tr_b16 v[112:113], v7 offset:61440
    ds_read_b64_tr_b16 v[114:115], v9 offset:45056
    v_mfma_f32_16x16x32_bf16 v[24:27], v[80:83], v[200:203], v[24:27]
    ds_read_b64_tr_b16 v[116:117], v8 offset:61440
    ds_read_b64_tr_b16 v[118:119], v10 offset:45056
    v_mfma_f32_16x16x32_bf16 v[24:27], v[88:91], v[212:215], v[24:27]
    s_waitcnt lgkmcnt(10)
    ds_read_b64_tr_b16 v[120:121], v9 offset:0
    ds_read_b64_tr_b16 v[122:123], v9 offset:4096
    v_mfma_f32_16x16x32_bf16 v[28:31], v[92:95], v[204:207], v[28:31]
    ds_read_b64_tr_b16 v[124:125], v10 offset:0
    ds_read_b64_tr_b16 v[126:127], v10 offset:4096
    v_mfma_f32_16x16x32_bf16 v[28:31], v[84:87], v[192:195], v[28:31]
    s_waitcnt lgkmcnt(10)
    ds_read_b64_tr_b16 v[128:129], v9 offset:8192
    ds_read_b64_tr_b16 v[130:131], v9 offset:12288
    v_mfma_f32_16x16x32_bf16 v[32:35], v[84:87], v[196:199], v[32:35]
    ds_read_b64_tr_b16 v[132:133], v10 offset:8192
    ds_read_b64_tr_b16 v[134:135], v10 offset:12288
    v_mfma_f32_16x16x32_bf16 v[32:35], v[92:95], v[208:211], v[32:35]
    s_waitcnt lgkmcnt(10)
    ds_read_b64_tr_b16 v[136:137], v9 offset:16384
    ds_read_b64_tr_b16 v[138:139], v9 offset:20480
    v_mfma_f32_16x16x32_bf16 v[36:39], v[92:95], v[212:215], v[36:39]
    ds_read_b64_tr_b16 v[140:141], v10 offset:16384
    ds_read_b64_tr_b16 v[142:143], v10 offset:20480
    v_mfma_f32_16x16x32_bf16 v[36:39], v[84:87], v[200:203], v[36:39]
    v_mfma_f32_16x16x32_bf16 v[16:19], v[96:99], v[40:43], v[16:19]
    s_waitcnt lgkmcnt(10)
    ds_read_b128 v[192:195], v15 offset:18432
    ds_read_b128 v[196:199], v15 offset:19456
    v_mfma_f32_16x16x32_bf16 v[16:19], v[104:107], v[52:55], v[16:19]
    ds_read_b128 v[200:203], v15 offset:20480
    ds_read_b128 v[204:207], v15 offset:21504
    v_mfma_f32_16x16x32_bf16 v[20:23], v[104:107], v[56:59], v[20:23]
    s_waitcnt lgkmcnt(10)
    ds_read_b128 v[208:211], v15 offset:22528
    ds_read_b128 v[212:215], v15 offset:23552
    v_mfma_f32_16x16x32_bf16 v[20:23], v[96:99], v[44:47], v[20:23]
    s_waitcnt lgkmcnt(6)
    s_barrier
    v_mfma_f32_16x16x32_bf16 v[24:27], v[96:99], v[48:51], v[24:27]
    s_add_u32 m0, s3, 0
    s_add_u32 s59, s50, 0
    v_mfma_f32_16x16x32_bf16 v[24:27], v[104:107], v[60:63], v[24:27]
    buffer_load_dwordx4 v3, s[12:15], s59 offen lds
    s_add_u32 m0, s3, 4096
    v_mfma_f32_16x16x32_bf16 v[28:31], v[108:111], v[52:55], v[28:31]
    s_add_u32 s59, s50, 4096
    buffer_load_dwordx4 v3, s[12:15], s59 offen lds
    v_mfma_f32_16x16x32_bf16 v[28:31], v[100:103], v[40:43], v[28:31]
    s_add_u32 m0, s3, 8192
    s_add_u32 s59, s50, 8192
    v_mfma_f32_16x16x32_bf16 v[32:35], v[100:103], v[44:47], v[32:35]
    buffer_load_dwordx4 v3, s[12:15], s59 offen lds
    s_add_u32 m0, s3, 12288
    v_mfma_f32_16x16x32_bf16 v[32:35], v[108:111], v[56:59], v[32:35]
    s_add_u32 s59, s50, 12288
    buffer_load_dwordx4 v3, s[12:15], s59 offen lds
    v_mfma_f32_16x16x32_bf16 v[36:39], v[108:111], v[60:63], v[36:39]
    v_mfma_f32_16x16x32_bf16 v[36:39], v[100:103], v[48:51], v[36:39]
    s_waitcnt lgkmcnt(0)
    v_mfma_f32_16x16x32_bf16 v[16:19], v[112:115], v[192:195], v[16:19]
    ds_read_b128 v[40:43], v15 offset:24576
    ds_read_b128 v[44:47], v15 offset:25600
    v_mfma_f32_16x16x32_bf16 v[16:19], v[120:123], v[204:207], v[16:19]
    ds_read_b128 v[48:51], v15 offset:26624
    ds_read_b128 v[52:55], v15 offset:27648
    v_mfma_f32_16x16x32_bf16 v[20:23], v[120:123], v[208:211], v[20:23]
    ds_read_b128 v[56:59], v15 offset:28672
    ds_read_b128 v[60:63], v15 offset:29696
    v_mfma_f32_16x16x32_bf16 v[20:23], v[112:115], v[196:199], v[20:23]
    s_add_u32 m0, s3, 16384
    s_add_u32 s59, s51, 0
    v_mfma_f32_16x16x32_bf16 v[24:27], v[112:115], v[200:203], v[24:27]
    buffer_load_dwordx4 v3, s[12:15], s59 offen lds
    s_add_u32 m0, s3, 20480
    v_mfma_f32_16x16x32_bf16 v[24:27], v[120:123], v[212:215], v[24:27]
    s_add_u32 s59, s51, 4096
    buffer_load_dwordx4 v3, s[12:15], s59 offen lds
    v_mfma_f32_16x16x32_bf16 v[28:31], v[124:127], v[204:207], v[28:31]
    s_add_u32 m0, s3, 24576
    s_add_u32 s59, s51, 8192
    v_mfma_f32_16x16x32_bf16 v[28:31], v[116:119], v[192:195], v[28:31]
    buffer_load_dwordx4 v3, s[12:15], s59 offen lds
    s_add_u32 m0, s3, 28672
    v_mfma_f32_16x16x32_bf16 v[32:35], v[116:119], v[196:199], v[32:35]
    s_add_u32 s59, s51, 12288
    buffer_load_dwordx4 v3, s[12:15], s59 offen lds
    v_mfma_f32_16x16x32_bf16 v[32:35], v[124:127], v[208:211], v[32:35]
    ds_read_b128 v[238:241], v251 offset:1536
    ds_read_b128 v[242:245], v251 offset:1792
    v_mfma_f32_16x16x32_bf16 v[36:39], v[124:127], v[212:215], v[36:39]
    ds_read_b128 v[246:249], v251 offset:2048
    v_mfma_f32_16x16x32_bf16 v[36:39], v[116:119], v[200:203], v[36:39]
    s_waitcnt lgkmcnt(3)
    v_mfma_f32_16x16x32_bf16 v[16:19], v[128:131], v[40:43], v[16:19]
    ds_read_b128 v[192:195], v15 offset:30720
    ds_read_b128 v[196:199], v15 offset:31744
    v_mfma_f32_16x16x32_bf16 v[16:19], v[136:139], v[52:55], v[16:19]
    ds_read_b128 v[200:203], v15 offset:32768
    ds_read_b128 v[204:207], v15 offset:33792
    v_mfma_f32_16x16x32_bf16 v[20:23], v[136:139], v[56:59], v[20:23]
    ds_read_b128 v[208:211], v15 offset:34816
    ds_read_b128 v[212:215], v15 offset:35840
    v_mfma_f32_16x16x32_bf16 v[20:23], v[128:131], v[44:47], v[20:23]
    ds_read_b64_tr_b16 v[144:145], v7 offset:32768
    ds_read_b64_tr_b16 v[146:147], v7 offset:36864
    v_mfma_f32_16x16x32_bf16 v[24:27], v[128:131], v[48:51], v[24:27]
    ds_read_b64_tr_b16 v[148:149], v8 offset:32768
    ds_read_b64_tr_b16 v[150:151], v8 offset:36864
    v_mfma_f32_16x16x32_bf16 v[24:27], v[136:139], v[60:63], v[24:27]
    ds_read_b64_tr_b16 v[152:153], v7 offset:40960
    s_waitcnt lgkmcnt(10)
    ds_read_b64_tr_b16 v[154:155], v7 offset:45056
    v_mfma_f32_16x16x32_bf16 v[28:31], v[140:143], v[52:55], v[28:31]
    ds_read_b64_tr_b16 v[156:157], v8 offset:40960
    ds_read_b64_tr_b16 v[158:159], v8 offset:45056
    v_mfma_f32_16x16x32_bf16 v[28:31], v[132:135], v[40:43], v[28:31]
    v_mfma_f32_16x16x32_bf16 v[32:35], v[132:135], v[44:47], v[32:35]
    v_mfma_f32_16x16x32_bf16 v[32:35], v[140:143], v[56:59], v[32:35]
    v_mfma_f32_16x16x32_bf16 v[36:39], v[140:143], v[60:63], v[36:39]
    v_mfma_f32_16x16x32_bf16 v[36:39], v[132:135], v[48:51], v[36:39]
    s_waitcnt lgkmcnt(8)
    s_waitcnt lgkmcnt(4)
    s_waitcnt lgkmcnt(0)
    v_mfma_f32_16x16x32_bf16 v[16:19], v[144:147], v[192:195], v[16:19]
    ds_read_b128 v[40:43], v15 offset:36864
    ds_read_b128 v[44:47], v15 offset:37888
    v_mfma_f32_16x16x32_bf16 v[16:19], v[152:155], v[204:207], v[16:19]
    ds_read_b128 v[48:51], v15 offset:38912
    ds_read_b128 v[52:55], v15 offset:39936
    v_mfma_f32_16x16x32_bf16 v[20:23], v[152:155], v[208:211], v[20:23]
    ds_read_b128 v[56:59], v15 offset:40960
    ds_read_b128 v[60:63], v15 offset:41984
    v_mfma_f32_16x16x32_bf16 v[20:23], v[144:147], v[196:199], v[20:23]
    v_add_f32 v238, v238, v239
    v_add_f32 v240, v240, v241
    v_mfma_f32_16x16x32_bf16 v[24:27], v[144:147], v[200:203], v[24:27]
    v_add_f32 v238, v238, v240
    v_rcp_f32 v232, v238
    v_mfma_f32_16x16x32_bf16 v[24:27], v[152:155], v[212:215], v[24:27]
    v_log_f32 v238, v238
    v_add_f32 v242, v242, v243
    v_mfma_f32_16x16x32_bf16 v[28:31], v[156:159], v[204:207], v[28:31]
    v_add_f32 v244, v244, v245
    v_add_f32 v242, v242, v244
    v_mfma_f32_16x16x32_bf16 v[28:31], v[148:151], v[192:195], v[28:31]
    v_rcp_f32 v233, v242
    v_log_f32 v242, v242
    v_mfma_f32_16x16x32_bf16 v[32:35], v[148:151], v[196:199], v[32:35]
    v_add_f32 v246, v246, v247
    v_add_f32 v248, v248, v249
    v_mfma_f32_16x16x32_bf16 v[32:35], v[156:159], v[208:211], v[32:35]
    v_add_f32 v246, v246, v248
    v_rcp_f32 v234, v246
    v_log_f32 v246, v246
    v_add_f32 v228, v238, v235
    v_add_f32 v229, v242, v236
    v_add_f32 v230, v246, v237
    v_min_u32 v228, -2, v228
    v_min_u32 v229, -2, v229
    v_min_u32 v230, -2, v230
    s_waitcnt vmcnt(0)
    s_barrier
    v_mfma_f32_16x16x32_bf16 v[36:39], v[156:159], v[212:215], v[36:39]
    ds_read_b64_tr_b16 v[160:161], v7 offset:0
    ds_read_b64_tr_b16 v[162:163], v7 offset:4096
    v_mfma_f32_16x16x32_bf16 v[36:39], v[148:151], v[200:203], v[36:39]
    ds_read_b64_tr_b16 v[164:165], v8 offset:0
    ds_read_b64_tr_b16 v[166:167], v8 offset:4096
    ds_read_b64_tr_b16 v[168:169], v7 offset:8192
    ds_read_b64_tr_b16 v[170:171], v7 offset:12288
    ds_read_b64_tr_b16 v[172:173], v8 offset:8192
    ds_read_b64_tr_b16 v[174:175], v8 offset:12288
    s_waitcnt lgkmcnt(8)
    s_waitcnt lgkmcnt(4)
    s_waitcnt lgkmcnt(0)
    v_mfma_f32_16x16x32_bf16 v[16:19], v[160:163], v[40:43], v[16:19]
    ds_read_b128 v[192:195], v15 offset:43008
    ds_read_b128 v[196:199], v15 offset:44032
    v_mfma_f32_16x16x32_bf16 v[16:19], v[168:171], v[52:55], v[16:19]
    ds_read_b128 v[200:203], v15 offset:45056
    ds_read_b128 v[204:207], v15 offset:46080
    v_mfma_f32_16x16x32_bf16 v[20:23], v[168:171], v[56:59], v[20:23]
    ds_read_b128 v[208:211], v15 offset:47104
    ds_read_b128 v[212:215], v15 offset:48128
    v_mfma_f32_16x16x32_bf16 v[20:23], v[160:163], v[44:47], v[20:23]
    ds_read_b64_tr_b16 v[176:177], v7 offset:16384
    ds_read_b64_tr_b16 v[178:179], v7 offset:20480
    v_mfma_f32_16x16x32_bf16 v[24:27], v[160:163], v[48:51], v[24:27]
    ds_read_b64_tr_b16 v[180:181], v8 offset:16384
    ds_read_b64_tr_b16 v[182:183], v8 offset:20480
    v_mfma_f32_16x16x32_bf16 v[24:27], v[168:171], v[60:63], v[24:27]
    ds_read_b64_tr_b16 v[184:185], v7 offset:24576
    ds_read_b64_tr_b16 v[186:187], v7 offset:28672
    v_mfma_f32_16x16x32_bf16 v[28:31], v[172:175], v[52:55], v[28:31]
    ds_read_b64_tr_b16 v[188:189], v8 offset:24576
    ds_read_b64_tr_b16 v[190:191], v8 offset:28672
    v_mfma_f32_16x16x32_bf16 v[28:31], v[164:167], v[40:43], v[28:31]
    v_mfma_f32_16x16x32_bf16 v[32:35], v[164:167], v[44:47], v[32:35]
    v_mfma_f32_16x16x32_bf16 v[32:35], v[172:175], v[56:59], v[32:35]
    v_mfma_f32_16x16x32_bf16 v[36:39], v[172:175], v[60:63], v[36:39]
    v_mfma_f32_16x16x32_bf16 v[36:39], v[164:167], v[48:51], v[36:39]
    s_waitcnt lgkmcnt(8)
    s_waitcnt lgkmcnt(4)
    s_waitcnt lgkmcnt(0)
    v_mfma_f32_16x16x32_bf16 v[16:19], v[176:179], v[192:195], v[16:19]
    v_mfma_f32_16x16x32_bf16 v[16:19], v[184:187], v[204:207], v[16:19]
    v_mfma_f32_16x16x32_bf16 v[20:23], v[184:187], v[208:211], v[20:23]
    v_mfma_f32_16x16x32_bf16 v[20:23], v[176:179], v[196:199], v[20:23]
    v_mfma_f32_16x16x32_bf16 v[24:27], v[176:179], v[200:203], v[24:27]
    v_mfma_f32_16x16x32_bf16 v[24:27], v[184:187], v[212:215], v[24:27]
    v_mfma_f32_16x16x32_bf16 v[28:31], v[188:191], v[204:207], v[28:31]
    v_mfma_f32_16x16x32_bf16 v[28:31], v[180:183], v[192:195], v[28:31]
    v_mfma_f32_16x16x32_bf16 v[32:35], v[180:183], v[196:199], v[32:35]
    v_mfma_f32_16x16x32_bf16 v[32:35], v[188:191], v[208:211], v[32:35]
    v_mfma_f32_16x16x32_bf16 v[36:39], v[188:191], v[212:215], v[36:39]
    v_mfma_f32_16x16x32_bf16 v[36:39], v[180:183], v[200:203], v[36:39]
    s_setprio 2
    v_add_u32 v15, 65536, v1
    v_mul_f32 v16, v16, v232
    v_mul_f32 v17, v17, v232
    v_mul_f32 v18, v18, v232
    v_mul_f32 v19, v19, v232
    v_cvt_pk_bf16_f32 v216, v16, v17
    v_cvt_pk_bf16_f32 v217, v18, v19
    v_min_u32 v216, -2, v216
    v_min_u32 v217, -2, v217
    v_mul_f32 v28, v28, v232
    v_mul_f32 v29, v29, v232
    v_mul_f32 v30, v30, v232
    v_mul_f32 v31, v31, v232
    v_cvt_pk_bf16_f32 v218, v28, v29
    v_cvt_pk_bf16_f32 v219, v30, v31
    v_min_u32 v218, -2, v218
    v_min_u32 v219, -2, v219
    v_mul_f32 v20, v20, v233
    v_mul_f32 v21, v21, v233
    v_mul_f32 v22, v22, v233
    v_mul_f32 v23, v23, v233
    v_cvt_pk_bf16_f32 v220, v20, v21
    v_cvt_pk_bf16_f32 v221, v22, v23
    v_min_u32 v220, -2, v220
    v_min_u32 v221, -2, v221
    v_mul_f32 v32, v32, v233
    v_mul_f32 v33, v33, v233
    v_mul_f32 v34, v34, v233
    v_mul_f32 v35, v35, v233
    v_cvt_pk_bf16_f32 v222, v32, v33
    v_cvt_pk_bf16_f32 v223, v34, v35
    v_min_u32 v222, -2, v222
    v_min_u32 v223, -2, v223
    v_mul_f32 v24, v24, v234
    v_mul_f32 v25, v25, v234
    v_mul_f32 v26, v26, v234
    v_mul_f32 v27, v27, v234
    v_cvt_pk_bf16_f32 v224, v24, v25
    v_cvt_pk_bf16_f32 v225, v26, v27
    v_min_u32 v224, -2, v224
    v_min_u32 v225, -2, v225
    v_mul_f32 v36, v36, v234
    v_mul_f32 v37, v37, v234
    v_mul_f32 v38, v38, v234
    v_mul_f32 v39, v39, v234
    v_cvt_pk_bf16_f32 v226, v36, v37
    v_cvt_pk_bf16_f32 v227, v38, v39
    v_min_u32 v226, -2, v226
    v_min_u32 v227, -2, v227
    v_mov_b32 v252, 0
    ds_write_b32 v250, v252 offset:12288
    s_cmp_eq_u32 s47, 0
    s_cbranch_scc1 L_slow_17
    buffer_store_dwordx4 v[216:219], v1, s[28:31], s52 offen offset:0
    buffer_store_dwordx4 v[220:223], v1, s[28:31], s52 offen offset:1024
    buffer_store_dwordx4 v[224:227], v1, s[28:31], s52 offen offset:2048
    s_mov_b64 exec, 0xffff
    buffer_store_dwordx4 v[228:231], v1, s[28:31], s52 offen offset:3072
    s_mov_b64 exec, -1
L_join_18:
    s_waitcnt lgkmcnt(0)
    s_setprio 0
    s_barrier
    ds_read_b128 v[40:43], v15 offset:24576
    ds_read_b128 v[44:47], v15 offset:25600
    ds_read_b128 v[48:51], v15 offset:26624
    ds_read_b128 v[52:55], v15 offset:27648
    ds_read_b128 v[56:59], v15 offset:28672
    ds_read_b128 v[60:63], v15 offset:29696
    s_waitcnt lgkmcnt(0)
    v_mfma_f32_16x16x32_bf16 v[16:19], v[128:131], v[40:43], 0
    ds_read_b128 v[192:195], v15 offset:30720
    ds_read_b128 v[196:199], v15 offset:31744
    v_mfma_f32_16x16x32_bf16 v[16:19], v[136:139], v[52:55], v[16:19]
    ds_read_b128 v[200:203], v15 offset:32768
    ds_read_b128 v[204:207], v15 offset:33792
    v_mfma_f32_16x16x32_bf16 v[20:23], v[136:139], v[56:59], 0
    ds_read_b128 v[208:211], v15 offset:34816
    ds_read_b128 v[212:215], v15 offset:35840
    v_mfma_f32_16x16x32_bf16 v[20:23], v[128:131], v[44:47], v[20:23]
    ds_read_b128 v[238:241], v251 offset:768
    ds_read_b128 v[242:245], v251 offset:1024
    v_mfma_f32_16x16x32_bf16 v[24:27], v[128:131], v[48:51], 0
    ds_read_b128 v[246:249], v251 offset:1280
    s_mul_i32 s3, s36, 3072
    v_mfma_f32_16x16x32_bf16 v[24:27], v[136:139], v[60:63], v[24:27]
    v_mfma_f32_16x16x32_bf16 v[28:31], v[140:143], v[52:55], 0
    v_mfma_f32_16x16x32_bf16 v[28:31], v[132:135], v[40:43], v[28:31]
    v_mfma_f32_16x16x32_bf16 v[32:35], v[132:135], v[44:47], 0
    v_mfma_f32_16x16x32_bf16 v[32:35], v[140:143], v[56:59], v[32:35]
    v_mfma_f32_16x16x32_bf16 v[36:39], v[140:143], v[60:63], 0
    v_mfma_f32_16x16x32_bf16 v[36:39], v[132:135], v[48:51], v[36:39]
    s_waitcnt lgkmcnt(3)
    v_mfma_f32_16x16x32_bf16 v[16:19], v[144:147], v[192:195], v[16:19]
    ds_read_b128 v[40:43], v15 offset:12288
    ds_read_b128 v[44:47], v15 offset:13312
    v_mfma_f32_16x16x32_bf16 v[16:19], v[152:155], v[204:207], v[16:19]
    ds_read_b128 v[48:51], v15 offset:14336
    ds_read_b128 v[52:55], v15 offset:15360
    v_mfma_f32_16x16x32_bf16 v[20:23], v[152:155], v[208:211], v[20:23]
    ds_read_b128 v[56:59], v15 offset:16384
    ds_read_b128 v[60:63], v15 offset:17408
    v_mfma_f32_16x16x32_bf16 v[20:23], v[144:147], v[196:199], v[20:23]
    s_waitcnt lgkmcnt(6)
    v_max3_f32 v238, v238, v239, v240
    v_mfma_f32_16x16x32_bf16 v[24:27], v[144:147], v[200:203], v[24:27]
    v_max_f32 v238, v238, v241
    v_mul_f32 v235, s45, v238
    v_mfma_f32_16x16x32_bf16 v[24:27], v[152:155], v[212:215], v[24:27]
    v_max3_f32 v242, v242, v243, v244
    v_max_f32 v242, v242, v245
    v_mfma_f32_16x16x32_bf16 v[28:31], v[156:159], v[204:207], v[28:31]
    v_mul_f32 v236, s45, v242
    v_max3_f32 v246, v246, v247, v248
    v_mfma_f32_16x16x32_bf16 v[28:31], v[148:151], v[192:195], v[28:31]
    v_max_f32 v246, v246, v249
    v_mul_f32 v237, s45, v246
    v_mfma_f32_16x16x32_bf16 v[32:35], v[148:151], v[196:199], v[32:35]
    ds_read_b128 v[238:241], v251 offset:2304
    ds_read_b128 v[242:245], v251 offset:2560
    v_mfma_f32_16x16x32_bf16 v[32:35], v[156:159], v[208:211], v[32:35]
    ds_read_b128 v[246:249], v251 offset:2816
    buffer_load_dwordx4 v[228:231], v4, s[28:31], s53 offen offset:3072 sc1
    v_mfma_f32_16x16x32_bf16 v[36:39], v[156:159], v[212:215], v[36:39]
    buffer_load_dwordx4 v[216:219], v1, s[28:31], s53 offen offset:0 sc1
    buffer_load_dwordx4 v[220:223], v1, s[28:31], s53 offen offset:1024 sc1
    v_mfma_f32_16x16x32_bf16 v[36:39], v[148:151], v[200:203], v[36:39]
    buffer_load_dwordx4 v[224:227], v1, s[28:31], s53 offen offset:2048 sc1
    s_waitcnt lgkmcnt(3)
    v_mfma_f32_16x16x32_bf16 v[16:19], v[96:99], v[40:43], v[16:19]
    ds_read_b128 v[192:195], v15 offset:18432
    ds_read_b128 v[196:199], v15 offset:19456
    v_mfma_f32_16x16x32_bf16 v[16:19], v[104:107], v[52:55], v[16:19]
    ds_read_b128 v[200:203], v15 offset:20480
    ds_read_b128 v[204:207], v15 offset:21504
    v_mfma_f32_16x16x32_bf16 v[20:23], v[104:107], v[56:59], v[20:23]
    ds_read_b128 v[208:211], v15 offset:22528
    ds_read_b128 v[212:215], v15 offset:23552
    v_mfma_f32_16x16x32_bf16 v[20:23], v[96:99], v[44:47], v[20:23]
    s_waitcnt lgkmcnt(6)
    v_add_f32 v238, v238, v239
    v_mfma_f32_16x16x32_bf16 v[24:27], v[96:99], v[48:51], v[24:27]
    v_add_f32 v240, v240, v241
    v_add_f32 v238, v238, v240
    v_mfma_f32_16x16x32_bf16 v[24:27], v[104:107], v[60:63], v[24:27]
    v_rcp_f32 v232, v238
    v_log_f32 v238, v238
    v_mfma_f32_16x16x32_bf16 v[28:31], v[108:111], v[52:55], v[28:31]
    v_add_f32 v242, v242, v243
    v_add_f32 v244, v244, v245
    v_mfma_f32_16x16x32_bf16 v[28:31], v[100:103], v[40:43], v[28:31]
    v_add_f32 v242, v242, v244
    v_rcp_f32 v233, v242
    v_mfma_f32_16x16x32_bf16 v[32:35], v[100:103], v[44:47], v[32:35]
    v_log_f32 v242, v242
    v_add_f32 v246, v246, v247
    v_mfma_f32_16x16x32_bf16 v[32:35], v[108:111], v[56:59], v[32:35]
    v_add_f32 v248, v248, v249
    v_add_f32 v246, v246, v248
    v_mfma_f32_16x16x32_bf16 v[36:39], v[108:111], v[60:63], v[36:39]
    v_rcp_f32 v234, v246
    v_log_f32 v246, v246
    v_mfma_f32_16x16x32_bf16 v[36:39], v[100:103], v[48:51], v[36:39]
    v_add_f32 v235, v238, v235
    v_add_f32 v236, v242, v236
    v_add_f32 v237, v246, v237
    s_waitcnt lgkmcnt(0)
    v_mfma_f32_16x16x32_bf16 v[16:19], v[112:115], v[192:195], v[16:19]
    ds_read_b128 v[40:43], v15 offset:36864
    ds_read_b128 v[44:47], v15 offset:37888
    v_mfma_f32_16x16x32_bf16 v[16:19], v[120:123], v[204:207], v[16:19]
    ds_read_b128 v[48:51], v15 offset:38912
    ds_read_b128 v[52:55], v15 offset:39936
    v_mfma_f32_16x16x32_bf16 v[20:23], v[120:123], v[208:211], v[20:23]
    ds_read_b128 v[56:59], v15 offset:40960
    ds_read_b128 v[60:63], v15 offset:41984
    v_mfma_f32_16x16x32_bf16 v[20:23], v[112:115], v[196:199], v[20:23]
    v_mfma_f32_16x16x32_bf16 v[24:27], v[112:115], v[200:203], v[24:27]
    v_mfma_f32_16x16x32_bf16 v[24:27], v[120:123], v[212:215], v[24:27]
    v_mfma_f32_16x16x32_bf16 v[28:31], v[124:127], v[204:207], v[28:31]
    v_mfma_f32_16x16x32_bf16 v[28:31], v[116:119], v[192:195], v[28:31]
    v_mfma_f32_16x16x32_bf16 v[32:35], v[116:119], v[196:199], v[32:35]
    v_mfma_f32_16x16x32_bf16 v[32:35], v[124:127], v[208:211], v[32:35]
    v_mfma_f32_16x16x32_bf16 v[36:39], v[124:127], v[212:215], v[36:39]
    v_mfma_f32_16x16x32_bf16 v[36:39], v[116:119], v[200:203], v[36:39]
    s_waitcnt lgkmcnt(0)
    v_mfma_f32_16x16x32_bf16 v[16:19], v[160:163], v[40:43], v[16:19]
    ds_read_b128 v[192:195], v15 offset:43008
    ds_read_b128 v[196:199], v15 offset:44032
    v_mfma_f32_16x16x32_bf16 v[16:19], v[168:171], v[52:55], v[16:19]
    ds_read_b128 v[200:203], v15 offset:45056
    ds_read_b128 v[204:207], v15 offset:46080
    v_mfma_f32_16x16x32_bf16 v[20:23], v[168:171], v[56:59], v[20:23]
    ds_read_b128 v[208:211], v15 offset:47104
    ds_read_b128 v[212:215], v15 offset:48128
    v_mfma_f32_16x16x32_bf16 v[20:23], v[160:163], v[44:47], v[20:23]
    v_mfma_f32_16x16x32_bf16 v[24:27], v[160:163], v[48:51], v[24:27]
    v_mfma_f32_16x16x32_bf16 v[24:27], v[168:171], v[60:63], v[24:27]
    v_mfma_f32_16x16x32_bf16 v[28:31], v[172:175], v[52:55], v[28:31]
    v_mfma_f32_16x16x32_bf16 v[28:31], v[164:167], v[40:43], v[28:31]
    v_mfma_f32_16x16x32_bf16 v[32:35], v[164:167], v[44:47], v[32:35]
    v_mfma_f32_16x16x32_bf16 v[32:35], v[172:175], v[56:59], v[32:35]
    v_mfma_f32_16x16x32_bf16 v[36:39], v[172:175], v[60:63], v[36:39]
    v_mfma_f32_16x16x32_bf16 v[36:39], v[164:167], v[48:51], v[36:39]
    s_waitcnt lgkmcnt(0)
    v_mfma_f32_16x16x32_bf16 v[16:19], v[176:179], v[192:195], v[16:19]
    ds_read_b128 v[40:43], v15 offset:0
    ds_read_b128 v[44:47], v15 offset:1024
    v_mfma_f32_16x16x32_bf16 v[16:19], v[184:187], v[204:207], v[16:19]
    ds_read_b128 v[48:51], v15 offset:2048
    ds_read_b128 v[52:55], v15 offset:3072
    v_mfma_f32_16x16x32_bf16 v[20:23], v[184:187], v[208:211], v[20:23]
    ds_read_b128 v[56:59], v15 offset:4096
    ds_read_b128 v[60:63], v15 offset:5120
    v_mfma_f32_16x16x32_bf16 v[20:23], v[176:179], v[196:199], v[20:23]
    v_mfma_f32_16x16x32_bf16 v[24:27], v[176:179], v[200:203], v[24:27]
    v_mfma_f32_16x16x32_bf16 v[24:27], v[184:187], v[212:215], v[24:27]
    v_mfma_f32_16x16x32_bf16 v[28:31], v[188:191], v[204:207], v[28:31]
    v_mfma_f32_16x16x32_bf16 v[28:31], v[180:183], v[192:195], v[28:31]
    v_mfma_f32_16x16x32_bf16 v[32:35], v[180:183], v[196:199], v[32:35]
    v_mfma_f32_16x16x32_bf16 v[32:35], v[188:191], v[208:211], v[32:35]
    v_mfma_f32_16x16x32_bf16 v[36:39], v[188:191], v[212:215], v[36:39]
    v_mfma_f32_16x16x32_bf16 v[36:39], v[180:183], v[200:203], v[36:39]
    s_waitcnt lgkmcnt(0)
    v_mfma_f32_16x16x32_bf16 v[16:19], v[64:67], v[40:43], v[16:19]
    ds_read_b128 v[192:195], v15 offset:6144
    ds_read_b128 v[196:199], v15 offset:7168
    v_mfma_f32_16x16x32_bf16 v[16:19], v[72:75], v[52:55], v[16:19]
    ds_read_b128 v[200:203], v15 offset:8192
    ds_read_b128 v[204:207], v15 offset:9216
    v_mfma_f32_16x16x32_bf16 v[20:23], v[72:75], v[56:59], v[20:23]
    ds_read_b128 v[208:211], v15 offset:10240
    ds_read_b128 v[212:215], v15 offset:11264
    s_mov_b32 s46, 0
L_pochk_19:
    s_waitcnt vmcnt(0)
    v_max3_u32 v246, v216, v217, v218
    v_max3_u32 v247, v219, v220, v221
    v_max3_u32 v246, v246, v222, v223
    v_max3_u32 v247, v247, v224, v225
    v_max3_u32 v246, v246, v226, v227
    v_max3_u32 v247, v247, v228, v229
    v_max3_u32 v246, v246, v230, v247
    v_cmp_eq_u32 vcc, -1, v246
    v_sub_f32 v243, v228, v235
    v_sub_f32 v244, v229, v236
    v_sub_f32 v245, v230, v237
    v_exp_f32 v243, v243
    v_exp_f32 v244, v244
    v_exp_f32 v245, v245
    s_cbranch_vccnz L_poreload_20
    v_mfma_f32_16x16x32_bf16 v[20:23], v[64:67], v[44:47], v[20:23]
    v_add_f32 v243, 1.0, v243
    v_add_f32 v244, 1.0, v244
    v_mfma_f32_16x16x32_bf16 v[24:27], v[64:67], v[48:51], v[24:27]
    v_add_f32 v245, 1.0, v245
    v_rcp_f32 v243, v243
    v_mfma_f32_16x16x32_bf16 v[24:27], v[72:75], v[60:63], v[24:27]
    v_rcp_f32 v244, v244
    v_rcp_f32 v245, v245
    v_mfma_f32_16x16x32_bf16 v[28:31], v[76:79], v[52:55], v[28:31]
    v_lshlrev_b32 v128, 16, v216
    v_and_b32 v129, 0xffff0000, v216
    v_mfma_f32_16x16x32_bf16 v[28:31], v[68:71], v[40:43], v[28:31]
    v_lshlrev_b32 v130, 16, v217
    v_and_b32 v131, 0xffff0000, v217
    v_mfma_f32_16x16x32_bf16 v[32:35], v[68:71], v[44:47], v[32:35]
    v_lshlrev_b32 v132, 16, v218
    v_and_b32 v133, 0xffff0000, v218
    v_mfma_f32_16x16x32_bf16 v[32:35], v[76:79], v[56:59], v[32:35]
    v_lshlrev_b32 v134, 16, v219
    v_and_b32 v135, 0xffff0000, v219
    v_mfma_f32_16x16x32_bf16 v[36:39], v[76:79], v[60:63], v[36:39]
    v_lshlrev_b32 v136, 16, v220
    v_and_b32 v137, 0xffff0000, v220
    v_mfma_f32_16x16x32_bf16 v[36:39], v[68:71], v[48:51], v[36:39]
    v_lshlrev_b32 v138, 16, v221
    v_and_b32 v139, 0xffff0000, v221
    v_lshlrev_b32 v140, 16, v222
    v_and_b32 v141, 0xffff0000, v222
    s_waitcnt lgkmcnt(0)
    v_mfma_f32_16x16x32_bf16 v[16:19], v[80:83], v[192:195], v[16:19]
    v_lshlrev_b32 v142, 16, v223
    v_and_b32 v143, 0xffff0000, v223
    v_mfma_f32_16x16x32_bf16 v[16:19], v[88:91], v[204:207], v[16:19]
    v_lshlrev_b32 v144, 16, v224
    v_and_b32 v145, 0xffff0000, v224
    v_mfma_f32_16x16x32_bf16 v[20:23], v[88:91], v[208:211], v[20:23]
    v_lshlrev_b32 v146, 16, v225
    v_and_b32 v147, 0xffff0000, v225
    v_mfma_f32_16x16x32_bf16 v[20:23], v[80:83], v[196:199], v[20:23]
    v_lshlrev_b32 v148, 16, v226
    v_and_b32 v149, 0xffff0000, v226
    v_mfma_f32_16x16x32_bf16 v[24:27], v[80:83], v[200:203], v[24:27]
    v_lshlrev_b32 v150, 16, v227
    v_and_b32 v151, 0xffff0000, v227
    v_mfma_f32_16x16x32_bf16 v[24:27], v[88:91], v[212:215], v[24:27]
    v_sub_f32 v240, 1.0, v243
    v_sub_f32 v241, 1.0, v244
    v_mfma_f32_16x16x32_bf16 v[28:31], v[92:95], v[204:207], v[28:31]
    v_sub_f32 v242, 1.0, v245
    v_mul_f32 v232, v232, v243
    v_mfma_f32_16x16x32_bf16 v[28:31], v[84:87], v[192:195], v[28:31]
    v_mul_f32 v246, v233, v244
    v_mul_f32 v248, v234, v245
    v_mfma_f32_16x16x32_bf16 v[32:35], v[84:87], v[196:199], v[32:35]
    v_mul_f32 v128, v128, v240
    v_mul_f32 v129, v129, v240
    v_mfma_f32_16x16x32_bf16 v[32:35], v[92:95], v[208:211], v[32:35]
    v_mul_f32 v130, v130, v240
    v_mul_f32 v131, v131, v240
    v_mfma_f32_16x16x32_bf16 v[36:39], v[92:95], v[212:215], v[36:39]
    v_mul_f32 v132, v132, v240
    v_mul_f32 v133, v133, v240
    v_mfma_f32_16x16x32_bf16 v[36:39], v[84:87], v[200:203], v[36:39]
    v_mul_f32 v134, v134, v240
    v_mul_f32 v135, v135, v240
    v_mul_f32 v136, v136, v241
    v_mul_f32 v137, v137, v241
    v_mul_f32 v138, v138, v241
    v_mul_f32 v139, v139, v241
    v_mul_f32 v140, v140, v241
    v_mul_f32 v141, v141, v241
    v_mul_f32 v142, v142, v241
    v_mul_f32 v143, v143, v241
    v_mul_f32 v144, v144, v242
    v_mul_f32 v145, v145, v242
    v_mul_f32 v146, v146, v242
    v_mul_f32 v147, v147, v242
    v_mul_f32 v148, v148, v242
    v_mul_f32 v149, v149, v242
    v_mul_f32 v150, v150, v242
    v_mul_f32 v151, v151, v242
    v_pk_fma_f32 v[128:129], v[16:17], v[232:233], v[128:129] op_sel_hi:[1,0,1]
    v_pk_fma_f32 v[130:131], v[18:19], v[232:233], v[130:131] op_sel_hi:[1,0,1]
    v_cvt_pk_bf16_f32 v216, v128, v129
    v_cvt_pk_bf16_f32 v217, v130, v131
    v_pk_fma_f32 v[132:133], v[28:29], v[232:233], v[132:133] op_sel_hi:[1,0,1]
    v_pk_fma_f32 v[134:135], v[30:31], v[232:233], v[134:135] op_sel_hi:[1,0,1]
    v_cvt_pk_bf16_f32 v218, v132, v133
    v_cvt_pk_bf16_f32 v219, v134, v135
    s_cmp_eq_u32 s47, 0
    s_cbranch_scc1 L_slow_21
    buffer_store_dwordx4 v[216:219], v1, s[28:31], s53 offen offset:0
L_join_22:
    v_pk_fma_f32 v[136:137], v[20:21], v[246:247], v[136:137] op_sel_hi:[1,0,1]
    v_pk_fma_f32 v[138:139], v[22:23], v[246:247], v[138:139] op_sel_hi:[1,0,1]
    v_cvt_pk_bf16_f32 v220, v136, v137
    v_cvt_pk_bf16_f32 v221, v138, v139
    v_pk_fma_f32 v[140:141], v[32:33], v[246:247], v[140:141] op_sel_hi:[1,0,1]
    v_pk_fma_f32 v[142:143], v[34:35], v[246:247], v[142:143] op_sel_hi:[1,0,1]
    v_cvt_pk_bf16_f32 v222, v140, v141
    v_cvt_pk_bf16_f32 v223, v142, v143
    s_cmp_eq_u32 s47, 0
    s_cbranch_scc1 L_slow_23
    buffer_store_dwordx4 v[220:223], v1, s[28:31], s53 offen offset:1024
L_join_24:
    v_pk_fma_f32 v[144:145], v[24:25], v[248:249], v[144:145] op_sel_hi:[1,0,1]
    v_pk_fma_f32 v[146:147], v[26:27], v[248:249], v[146:147] op_sel_hi:[1,0,1]
    v_cvt_pk_bf16_f32 v224, v144, v145
    v_cvt_pk_bf16_f32 v225, v146, v147
    v_pk_fma_f32 v[148:149], v[36:37], v[248:249], v[148:149] op_sel_hi:[1,0,1]
    v_pk_fma_f32 v[150:151], v[38:39], v[248:249], v[150:151] op_sel_hi:[1,0,1]
    v_cvt_pk_bf16_f32 v226, v148, v149
    v_cvt_pk_bf16_f32 v227, v150, v151
    s_cmp_eq_u32 s47, 0
    s_cbranch_scc1 L_slow_25
    buffer_store_dwordx4 v[224:227], v1, s[28:31], s53 offen offset:2048
L_join_26:
    ds_write_b32 v250, v255 offset:12288
    v_mov_b32 v240, -1
    v_mov_b32 v241, -1
    v_mov_b32 v242, -1
    v_mov_b32 v243, -1
    s_lshl2_add_u32 s56, s41, s36
    s_lshl3_add_u32 s56, s56, s40
    s_mul_i32 s57, s56, 24576
    s_mul_i32 s58, s37, 3072
    s_add_u32 s57, s57, s58
    s_add_u32 s57, s57, 8388608
    s_lshl_b32 s49, s56, 7
    s_add_u32 s49, s49, s37
    s_cmp_eq_u32 s36, s37
    s_cselect_b32 s48, 0x10000000, s57
    s_waitcnt vmcnt(0)
    s_cmp_eq_u32 s47, 0
    s_cbranch_scc1 L_slow_27
    buffer_store_byte v255, v254, s[28:31], s69 offen
L_join_28:
    s_mov_b32 s46, 0
L_lw_29:
    s_add_u32 s46, s46, 1
    s_cmp_gt_u32 s46, 1048576
    s_cbranch_scc1 L_end
    ds_read_b128 v[16:19], v251 offset:12288
    s_waitcnt lgkmcnt(0)
    v_and_b32 v16, v16, v17
    v_and_b32 v18, v18, v19
    v_and_b32 v16, v16, v18
    s_nop 0
    v_readfirstlane_b32 s56, v16
    s_bitcmp1_b32 s56, 0
    s_cbranch_scc0 L_lw_29
    s_mov_b32 s46, 0
L_of_30:
    s_add_u32 s46, s46, 1
    s_cmp_gt_u32 s46, 1048576
    s_cbranch_scc1 L_end
    buffer_load_dword v16, v5, s[28:31], s0 offen sc1
    s_waitcnt vmcnt(0)
    v_cmp_ne_u32 vcc, 0x01010101, v16
    s_nop 4
    s_cbranch_vccnz L_of_30
    s_add_u32 m0, s3, 65536
    s_nop 0
    buffer_load_dwordx4 v1, s[28:31], s8 offen offset:0 sc1 lds
    buffer_load_dwordx4 v1, s[28:31], s8 offen offset:1024 sc1 lds
    buffer_load_dwordx4 v1, s[28:31], s8 offen offset:2048 sc1 lds
    s_add_u32 m0, s3, 77824
    s_nop 0
    buffer_load_dwordx4 v1, s[28:31], s9 offen offset:0 sc1 lds
    buffer_load_dwordx4 v1, s[28:31], s9 offen offset:1024 sc1 lds
    buffer_load_dwordx4 v1, s[28:31], s9 offen offset:2048 sc1 lds
    s_add_u32 m0, s3, 90112
    s_nop 0
    buffer_load_dwordx4 v1, s[28:31], s10 offen offset:0 sc1 lds
    buffer_load_dwordx4 v1, s[28:31], s10 offen offset:1024 sc1 lds
    buffer_load_dwordx4 v1, s[28:31], s10 offen offset:2048 sc1 lds
    s_add_u32 m0, s3, 102400
    s_nop 0
    buffer_load_dwordx4 v1, s[28:31], s11 offen offset:0 sc1 lds
    buffer_load_dwordx4 v1, s[28:31], s11 offen offset:1024 sc1 lds
    buffer_load_dwordx4 v1, s[28:31], s11 offen offset:2048 sc1 lds
    s_waitcnt vmcnt(9)
    s_barrier
    s_add_u32 m0, s3, 114688
    s_nop 0
    buffer_load_dwordx4 v1, s[28:31], s16 offen offset:0 sc1 lds
    buffer_load_dwordx4 v1, s[28:31], s16 offen offset:1024 sc1 lds
    buffer_load_dwordx4 v1, s[28:31], s16 offen offset:2048 sc1 lds
    s_add_u32 m0, s3, 126976
    s_nop 0
    buffer_load_dwordx4 v1, s[28:31], s17 offen offset:0 sc1 lds
    buffer_load_dwordx4 v1, s[28:31], s17 offen offset:1024 sc1 lds
    buffer_load_dwordx4 v1, s[28:31], s17 offen offset:2048 sc1 lds
    s_waitcnt vmcnt(9)
    s_barrier
    s_add_u32 m0, s3, 139264
    s_nop 0
    buffer_load_dwordx4 v1, s[28:31], s18 offen offset:0 sc1 lds
    buffer_load_dwordx4 v1, s[28:31], s18 offen offset:1024 sc1 lds
    buffer_load_dwordx4 v1, s[28:31], s18 offen offset:2048 sc1 lds
    s_add_u32 m0, s3, 151552
    s_nop 0
    buffer_load_dwordx4 v1, s[28:31], s19 offen offset:0 sc1 lds
    buffer_load_dwordx4 v1, s[28:31], s19 offen offset:1024 sc1 lds
    buffer_load_dwordx4 v1, s[28:31], s19 offen offset:2048 sc1 lds
    s_waitcnt vmcnt(6)
    s_barrier
    buffer_store_dwordx4 v[240:243], v1, s[28:31], s48 offen offset:0 sc1
    buffer_store_dwordx4 v[240:243], v1, s[28:31], s48 offen offset:1024 sc1
    buffer_store_dwordx4 v[240:243], v1, s[28:31], s48 offen offset:2048 sc1
    s_waitcnt vmcnt(3)
    s_barrier
    s_andn2_b32 s56, s49, 3
    s_add_u32 s34, s28, s56
    s_addc_u32 s35, s29, 0
    s_lshl_b32 s56, s49, 3
    s_lshl_b32 s33, 1, s56
    s_waitcnt vmcnt(0)
    s_atomic_or s33, s[34:35], 4
    s_barrier
    s_cmp_eq_u32 s36, 3
    s_cbranch_scc1 L_a3
    s_mul_i32 s57, s43, 24576
    s_lshl_b32 s56, s36, 10
    s_add_u32 s57, s57, s56
    s_add_u32 s57, s57, 8388608
    s_add_u32 s58, s37, 1
    s_and_b32 s58, s58, 3
    s_mul_i32 s58, s58, 3072
    s_add_u32 s49, s58, s57
    s_add_u32 s58, s37, 2
    s_and_b32 s58, s58, 3
    s_mul_i32 s58, s58, 3072
    s_add_u32 s50, s58, s57
    s_add_u32 s58, s37, 3
    s_and_b32 s58, s58, 3
    s_mul_i32 s58, s58, 3072
    s_add_u32 s51, s58, s57
    s_add_u32 s53, s57, 12288
    s_add_u32 s54, s57, 18432
    v_add_u32 v14, s56, v1
    v_and_b32 v2, 15, v0
    v_lshlrev_b32 v2, 11, v2
    v_bfe_u32 v3, v0, 4, 1
    v_lshl_or_b32 v2, v3, 5, v2
    v_lshrrev_b32 v3, 5, v0
    v_lshl_or_b32 v2, v3, 4, v2
    s_mul_i32 s52, s41, 98304
    s_lshl_b32 s56, s40, 8
    s_add_u32 s52, s52, s56
    s_lshl_b32 s56, s37, 6
    s_add_u32 s52, s52, s56
    s_lshl_b32 s56, s36, 15
    s_add_u32 s52, s52, s56
    s_lshl_b32 s58, s43, 7
    s_add_u32 s34, s28, s58
    s_addc_u32 s35, s29, 0
    s_waitcnt lgkmcnt(0)
    s_mov_b32 s46, 0
L_poll_31:
    s_add_u32 s46, s46, 1
    s_cmp_gt_u32 s46, 1048576
    s_cbranch_scc1 L_end
    s_load_dwordx2 s[60:61], s[34:35], 4 glc
    s_waitcnt lgkmcnt(0)
    s_and_b32 s60, s60, s61
    s_cmp_eq_u32 s60, 0x01010101
    s_cbranch_scc0 L_poll_31
    buffer_load_dwordx4 v[64:67], v1, s[28:31], s53 offen offset:0 sc1
    buffer_load_dwordx4 v[68:71], v1, s[28:31], s53 offen offset:3072 sc1
    buffer_load_dwordx4 v[72:75], v1, s[28:31], s54 offen offset:0 sc1
    buffer_load_dwordx4 v[76:79], v1, s[28:31], s54 offen offset:3072 sc1
    s_barrier
    ds_read_b128 v[16:19], v14 offset:0
    ds_read_b128 v[20:23], v14 offset:3072
    buffer_load_dwordx4 v[32:35], v1, s[28:31], s49 offen sc1
    buffer_load_dwordx4 v[36:39], v1, s[28:31], s50 offen sc1
    buffer_load_dwordx4 v[40:43], v1, s[28:31], s51 offen sc1
    s_waitcnt lgkmcnt(0)
    s_waitcnt vmcnt(3)
    v_lshlrev_b32 v4, 16, v64
    v_and_b32 v5, 0xffff0000, v64
    v_pk_add_f32 v[16:17], v[16:17], v[4:5]
    v_lshlrev_b32 v4, 16, v65
    v_and_b32 v5, 0xffff0000, v65
    v_pk_add_f32 v[18:19], v[18:19], v[4:5]
    v_lshlrev_b32 v4, 16, v66
    v_and_b32 v5, 0xffff0000, v66
    v_pk_add_f32 v[20:21], v[20:21], v[4:5]
    v_lshlrev_b32 v4, 16, v67
    v_and_b32 v5, 0xffff0000, v67
    v_pk_add_f32 v[22:23], v[22:23], v[4:5]
    v_lshlrev_b32 v4, 16, v68
    v_and_b32 v5, 0xffff0000, v68
    v_pk_add_f32 v[16:17], v[16:17], v[4:5]
    v_lshlrev_b32 v4, 16, v69
    v_and_b32 v5, 0xffff0000, v69
    v_pk_add_f32 v[18:19], v[18:19], v[4:5]
    v_lshlrev_b32 v4, 16, v70
    v_and_b32 v5, 0xffff0000, v70
    v_pk_add_f32 v[20:21], v[20:21], v[4:5]
    v_lshlrev_b32 v4, 16, v71
    v_and_b32 v5, 0xffff0000, v71
    v_pk_add_f32 v[22:23], v[22:23], v[4:5]
    v_lshlrev_b32 v4, 16, v72
    v_and_b32 v5, 0xffff0000, v72
    v_pk_add_f32 v[16:17], v[16:17], v[4:5]
    v_lshlrev_b32 v4, 16, v73
    v_and_b32 v5, 0xffff0000, v73
    v_pk_add_f32 v[18:19], v[18:19], v[4:5]
    v_lshlrev_b32 v4, 16, v74
    v_and_b32 v5, 0xffff0000, v74
    v_pk_add_f32 v[20:21], v[20:21], v[4:5]
    v_lshlrev_b32 v4, 16, v75
    v_and_b32 v5, 0xffff0000, v75
    v_pk_add_f32 v[22:23], v[22:23], v[4:5]
    v_lshlrev_b32 v4, 16, v76
    v_and_b32 v5, 0xffff0000, v76
    v_pk_add_f32 v[16:17], v[16:17], v[4:5]
    v_lshlrev_b32 v4, 16, v77
    v_and_b32 v5, 0xffff0000, v77
    v_pk_add_f32 v[18:19], v[18:19], v[4:5]
    v_lshlrev_b32 v4, 16, v78
    v_and_b32 v5, 0xffff0000, v78
    v_pk_add_f32 v[20:21], v[20:21], v[4:5]
    v_lshlrev_b32 v4, 16, v79
    v_and_b32 v5, 0xffff0000, v79
    v_pk_add_f32 v[22:23], v[22:23], v[4:5]
    s_mov_b32 s46, 0
L_s2c_32:
    s_waitcnt vmcnt(0)
    v_max3_u32 v4, v32, v33, v34
    v_max3_u32 v5, v35, v36, v37
    v_max3_u32 v4, v4, v38, v39
    v_max3_u32 v5, v5, v40, v41
    v_max3_u32 v4, v4, v42, v43
    v_max_u32 v4, v4, v5
    v_cmp_eq_u32 vcc, -1, v4
    v_lshlrev_b32 v64, 16, v32
    v_lshlrev_b32 v66, 16, v33
    v_lshlrev_b32 v68, 16, v34
    v_lshlrev_b32 v70, 16, v35
    v_lshlrev_b32 v72, 16, v36
    s_cbranch_vccnz L_s2l_33
    v_lshlrev_b32 v74, 16, v37
    v_lshlrev_b32 v76, 16, v38
    v_lshlrev_b32 v78, 16, v39
    v_lshlrev_b32 v80, 16, v40
    v_lshlrev_b32 v82, 16, v41
    v_lshlrev_b32 v84, 16, v42
    v_lshlrev_b32 v86, 16, v43
    v_and_b32 v65, 0xffff0000, v32
    v_and_b32 v67, 0xffff0000, v33
    v_and_b32 v69, 0xffff0000, v34
    v_and_b32 v71, 0xffff0000, v35
    v_and_b32 v73, 0xffff0000, v36
    v_and_b32 v75, 0xffff0000, v37
    v_and_b32 v77, 0xffff0000, v38
    v_and_b32 v79, 0xffff0000, v39
    v_and_b32 v81, 0xffff0000, v40
    v_and_b32 v83, 0xffff0000, v41
    v_and_b32 v85, 0xffff0000, v42
    v_and_b32 v87, 0xffff0000, v43
    v_pk_add_f32 v[16:17], v[16:17], v[64:65]
    v_pk_add_f32 v[18:19], v[18:19], v[66:67]
    v_pk_add_f32 v[20:21], v[20:21], v[68:69]
    v_pk_add_f32 v[22:23], v[22:23], v[70:71]
    v_pk_add_f32 v[16:17], v[16:17], v[72:73]
    v_pk_add_f32 v[18:19], v[18:19], v[74:75]
    v_pk_add_f32 v[20:21], v[20:21], v[76:77]
    v_pk_add_f32 v[22:23], v[22:23], v[78:79]
    v_pk_add_f32 v[16:17], v[16:17], v[80:81]
    v_pk_add_f32 v[18:19], v[18:19], v[82:83]
    v_pk_add_f32 v[20:21], v[20:21], v[84:85]
    v_pk_add_f32 v[22:23], v[22:23], v[86:87]
    v_cvt_pk_bf16_f32 v24, v16, v17
    v_cvt_pk_bf16_f32 v25, v18, v19
    v_cvt_pk_bf16_f32 v26, v20, v21
    v_cvt_pk_bf16_f32 v27, v22, v23
    s_nop 0
    v_permlane16_swap_b32 v24, v26
    v_permlane16_swap_b32 v25, v27
    buffer_store_dwordx4 v[24:27], v2, s[24:27], s52 offen sc1
    s_endpgm
L_a3:
    s_barrier
    s_endpgm
L_slow_4:
    buffer_store_dwordx4 v[240:243], v1, s[28:31], s32 offen offset:0 sc1
    buffer_store_dwordx4 v[240:243], v1, s[28:31], s32 offen offset:1024 sc1
    buffer_store_dwordx4 v[240:243], v1, s[28:31], s32 offen offset:2048 sc1
    s_mov_b64 exec, 0xffff
    buffer_store_dwordx4 v[240:243], v1, s[28:31], s32 offen offset:3072 sc1
    s_mov_b64 exec, -1
    s_nop 0
    s_branch L_join_5
L_cfpoll_6:
    s_add_u32 s46, s46, 1
    s_cmp_gt_u32 s46, 1048576
    s_cbranch_scc1 L_end
    s_load_dword s60, s[34:35], 12 glc
    s_branch L_cfok_7
L_slow_13:
    buffer_store_dwordx4 v[216:219], v1, s[28:31], s53 offen offset:0 sc1
    buffer_store_dwordx4 v[220:223], v1, s[28:31], s53 offen offset:1024 sc1
    buffer_store_dwordx4 v[224:227], v1, s[28:31], s53 offen offset:2048 sc1
    s_nop 0
    s_branch L_join_14
L_slow_15:
    buffer_store_byte v255, v254, s[28:31], s68 offen offset:0 sc1
    s_nop 0
    s_branch L_join_16
L_slow_17:
    buffer_store_dwordx4 v[216:219], v1, s[28:31], s52 offen offset:0 sc1
    buffer_store_dwordx4 v[220:223], v1, s[28:31], s52 offen offset:1024 sc1
    buffer_store_dwordx4 v[224:227], v1, s[28:31], s52 offen offset:2048 sc1
    s_mov_b64 exec, 0xffff
    buffer_store_dwordx4 v[228:231], v1, s[28:31], s52 offen offset:3072 sc1
    s_mov_b64 exec, -1
    s_nop 0
    s_branch L_join_18
L_poreload_20:
    s_add_u32 s46, s46, 1
    s_cmp_gt_u32 s46, 1048576
    s_cbranch_scc1 L_end
    buffer_load_dwordx4 v[228:231], v4, s[28:31], s53 offen offset:3072 sc1
    buffer_load_dwordx4 v[216:219], v1, s[28:31], s53 offen offset:0 sc1
    buffer_load_dwordx4 v[220:223], v1, s[28:31], s53 offen offset:1024 sc1
    buffer_load_dwordx4 v[224:227], v1, s[28:31], s53 offen offset:2048 sc1
    s_branch L_pochk_19
L_slow_21:
    buffer_store_dwordx4 v[216:219], v1, s[28:31], s53 offen offset:0 sc1
    s_nop 0
    s_branch L_join_22
L_slow_23:
    buffer_store_dwordx4 v[220:223], v1, s[28:31], s53 offen offset:1024 sc1
    s_nop 0
    s_branch L_join_24
L_slow_25:
    buffer_store_dwordx4 v[224:227], v1, s[28:31], s53 offen offset:2048 sc1
    s_nop 0
    s_branch L_join_26
L_slow_27:
    buffer_store_byte v255, v254, s[28:31], s69 offen sc1
    s_nop 0
    s_branch L_join_28
L_s2l_33:
    s_add_u32 s46, s46, 1
    s_cmp_gt_u32 s46, 1048576
    s_cbranch_scc1 L_end
    buffer_load_dwordx4 v[32:35], v1, s[28:31], s49 offen sc1
    buffer_load_dwordx4 v[36:39], v1, s[28:31], s50 offen sc1
    buffer_load_dwordx4 v[40:43], v1, s[28:31], s51 offen sc1
    s_branch L_s2c_32
L_codeend:
    s_endpgm
.section .rodata,"a"
.p2align 6
.amdhsa_kernel standalone__gqa_block_cached__near_ridge_kernel
  .amdhsa_next_free_vgpr 256
  .amdhsa_next_free_sgpr 102
  .amdhsa_accum_offset 256
  .amdhsa_group_segment_fixed_size 0
  .amdhsa_kernarg_size 64
  .amdhsa_user_sgpr_count 2
  .amdhsa_user_sgpr_kernarg_segment_ptr 1
  .amdhsa_system_sgpr_workgroup_id_x 1
.end_amdhsa_kernel
```
